```python
import torch

def _softmax(x, axis=-1):
    return torch.softmax(x, dim=axis)
def _gelu(x):
    return torch.nn.functional.gelu(x, approximate="tanh")
def _silu(x):
    return torch.nn.functional.silu(x)
def _sigmoid(x):
    return torch.sigmoid(x)
def _layernorm(x, axis=-1, eps=1e-5):
    m = x.mean(dim=axis, keepdim=True)
    v = x.var(dim=axis, keepdim=True, unbiased=False)
    return (x - m) / torch.sqrt(v + eps)
def _scatter_add(tgt, idx, src, axis=0):
    return tgt.clone().index_add_(axis, idx, src)
def _segment_sum(src, seg, n):
    out = torch.zeros((n,) + src.shape[1:], dtype=src.dtype)
    return out.index_add_(0, seg, src)
def _pad(x, pw):
    flat = tuple(v for pair in reversed(pw) for v in pair)
    return torch.nn.functional.pad(x, flat)

kernel_name = 'sequential_preLN__compressed_kv_cla__swiglu_ffn__decode'

def setup_inputs():

    _w = (lambda a: (lambda t: t.to(torch.bfloat16) if t.is_floating_point() else t)(torch.as_tensor(a)))
    def _A_setup():
        B, H, Sq, Sk, D, M = 2, 32, 1, 4096, 128, 576
        Dc = 4 * D
        return {
            "x": _w((lambda *s: torch.randn(*s, dtype=torch.bfloat16) * 0.05)(B, Sq, M)),
            "c_kv": _w((lambda *s: torch.randn(*s, dtype=torch.bfloat16) * 0.4)(B, Sk, Dc)),
            "w_q": _w((lambda *s: torch.randn(*s, dtype=torch.bfloat16) * 3.2)(M, H, D) * (M ** -0.5)),
            "w_uk": _w((lambda *s: torch.randn(*s, dtype=torch.bfloat16) * 3.2)(Dc, H, D) * (Dc ** -0.5)),
            "w_uv": _w((lambda *s: torch.randn(*s, dtype=torch.bfloat16) * 0.4)(Dc, H, D) * (Dc ** -0.5)),
            "w_o": _w((lambda *s: torch.randn(*s, dtype=torch.bfloat16) * 0.4)(H, D, M) * ((H * D) ** -0.5)),
        }
    _A_in = _A_setup()

    def _B_setup():
        B, S, D, F = 2, 1, 576, 4608
        return {
            "x": _w((lambda *s: torch.randn(*s, dtype=torch.bfloat16) * 0.05)(B, S, D)),
            "w_gate": _w((lambda *s: torch.randn(*s, dtype=torch.bfloat16) * 0.05)(D, F)),
            "w_up": _w((lambda *s: torch.randn(*s, dtype=torch.bfloat16) * 0.05)(D, F)),
            "w_down": _w((lambda *s: torch.randn(*s, dtype=torch.bfloat16) * 0.05)(F, D)),
        }
    _B_in = _B_setup()

    return {
        "A_x": _A_in["x"],
        "A_c_kv": _A_in["c_kv"],
        "A_w_q": _A_in["w_q"],
        "A_w_uk": _A_in["w_uk"],
        "A_w_uv": _A_in["w_uv"],
        "A_w_o": _A_in["w_o"],
        "B_x": _B_in["x"],
        "B_w_gate": _B_in["w_gate"],
        "B_w_up": _B_in["w_up"],
        "B_w_down": _B_in["w_down"],
    }

def reference(A_x, A_c_kv, A_w_q, A_w_uk, A_w_uv, A_w_o, B_x, B_w_gate, B_w_up, B_w_down):
    def _A_ref(x, c_kv, w_q, w_uk, w_uv, w_o):
        B, Sq, M = x.shape[0], x.shape[1], x.shape[2]
        Sk = c_kv.shape[1]
        H, D = w_q.shape[1], w_q.shape[2]
        q = torch.einsum("bqm,mhd->bhqd", x, w_q)
        k = torch.einsum("bkc,chd->bhkd", c_kv, w_uk)
        v = torch.einsum("bkc,chd->bhkd", c_kv, w_uv)
        scores = torch.einsum("bhqd,bhkd->bhqk", q, k) * (D ** -0.5)
        off = Sk - Sq
        qi = torch.arange(Sq)[:, None]
        kj = torch.arange(Sk)[None, :]
        cmask = kj <= (qi + off)
        scores = torch.where(cmask[None, None], scores, -1e9)
        p = _softmax(scores, axis=-1)
        ctx = torch.einsum("bhqk,bhkd->bhqd", p, v)
        return torch.einsum("bhqd,hdm->bqm", ctx, w_o)

    def _B_ref(x, w_gate, w_up, w_down):
        g = _silu(x @ w_gate)
        u = x @ w_up
        return (g * u) @ w_down

    x = A_x
    h = x + _A_ref(_layernorm(x, axis=-1), A_c_kv, A_w_q, A_w_uk, A_w_uv, A_w_o)
    h2 = h + _B_ref(_layernorm(h, axis=-1), B_w_gate, B_w_up, B_w_down)
    return h2
```

```asm
; @launch grid=(256,1,1) block=(768,1,1) lds=160576
.amdgcn_target "amdgcn-amd-amdhsa--gfx950"
.text
.globl sequential_preLN__compressed_kv_cla__swiglu_ffn__decode_kernel
.p2align 8
.type sequential_preLN__compressed_kv_cla__swiglu_ffn__decode_kernel,@function
sequential_preLN__compressed_kv_cla__swiglu_ffn__decode_kernel:
    s_cmp_ge_u32 s2, 256
    s_cbranch_scc1 L_end
    s_load_dwordx16 s[4:19], s[0:1], 0
    s_load_dwordx8 s[20:27], s[0:1], 64
    s_load_dwordx2 s[30:31], s[0:1], 96
    v_lshrrev_b32 v1, 6, v0
    v_and_b32 v2, 63, v0
    v_readfirstlane_b32 s80, v1
    v_and_b32 v3, 15, v2
    v_lshrrev_b32 v4, 4, v2
    s_and_b32 s81, s2, 7
    s_lshr_b32 s82, s2, 3
    s_mov_b32 s94, 0
    s_waitcnt lgkmcnt(0)
    s_mov_b32 s32, s4
    s_mov_b32 s33, s5
    s_mov_b32 s34, 2304
    s_mov_b32 s35, 0x00020000
    s_mov_b32 s36, s6
    s_mov_b32 s37, s7
    s_mov_b32 s38, 8388608
    s_mov_b32 s39, 0x00020000
    s_mov_b32 s40, s8
    s_mov_b32 s41, s9
    s_mov_b32 s42, 4718592
    s_mov_b32 s43, 0x00020000
    s_mov_b32 s44, s10
    s_mov_b32 s45, s11
    s_mov_b32 s46, 4194304
    s_mov_b32 s47, 0x00020000
    s_mov_b32 s48, s12
    s_mov_b32 s49, s13
    s_mov_b32 s50, 4194304
    s_mov_b32 s51, 0x00020000
    s_mov_b32 s52, s14
    s_mov_b32 s53, s15
    s_mov_b32 s54, 4718592
    s_mov_b32 s55, 0x00020000
    s_mov_b32 s56, s18
    s_mov_b32 s57, s19
    s_mov_b32 s58, 5308416
    s_mov_b32 s59, 0x00020000
    s_mov_b32 s60, s20
    s_mov_b32 s61, s21
    s_mov_b32 s62, 5308416
    s_mov_b32 s63, 0x00020000
    s_mov_b32 s64, s22
    s_mov_b32 s65, s23
    s_mov_b32 s66, 5308416
    s_mov_b32 s67, 0x00020000
    s_mov_b32 s68, s24
    s_mov_b32 s69, s25
    s_mov_b32 s70, 2304
    s_mov_b32 s71, 0x00020000
    s_mov_b32 s72, s26
    s_mov_b32 s73, s27
    s_mov_b32 s74, 256
    s_mov_b32 s75, 0x00020000
    s_mov_b32 s76, s30
    s_mov_b32 s77, s31
    s_mov_b32 s78, 268435456
    s_mov_b32 s79, 0x00020000
    s_mov_b32 s28, s26
    s_mov_b32 s29, s27
    s_add_u32 s92, s30, 10485760
    s_addc_u32 s93, s31, 0
    s_load_dwordx2 s[0:1], s[92:93], 0
    s_cmp_ge_u32 s82, 16
    s_cbranch_scc1 L_X
    s_lshr_b32 s90, s82, 2
    s_lshl_b32 s83, s81, 2
    s_add_u32 s83, s83, s90
    s_and_b32 s90, s82, 3
    s_lshl_b32 s84, s90, 1
    s_and_b32 s91, s80, 1
    s_add_u32 s84, s84, s91
    s_cmp_ge_u32 s80, 4
    s_cbranch_scc1 L_Ytile
    s_cmp_ge_u32 s80, 2
    s_cbranch_scc1 L_Y23
    s_cmp_eq_u32 s80, 1
    s_cbranch_scc1 L_Y1_pre
    s_mov_b32 s86, s83
    s_and_b32 s87, s82, 3
L_S1:
    v_lshrrev_b32 v5, 5, v2
    v_and_b32 v6, 31, v2
    v_mul_u32_u24 v6, 36, v6
    s_movk_i32 s90, 1152
    v_mad_u32_u24 v5, v5, s90, v6
    buffer_load_dwordx4 v[16:19], v5, s[32:35], 0 offen
    buffer_load_dwordx4 v[20:23], v5, s[32:35], 0 offen offset:16
    buffer_load_dword v24, v5, s[32:35], 0 offen offset:32
    v_mul_u32_u24 v6, 576, v4
    v_lshlrev_b32 v6, 8, v6
    v_lshl_add_u32 v6, v3, 4, v6
    s_mul_i32 s90, s87, 589824
    s_lshl_b32 s91, s86, 8
    s_add_u32 s90, s90, s91
    buffer_load_dwordx4 v[48:51], v6, s[40:43], s90 offen
    s_add_u32 s90, s90, 8192
    buffer_load_dwordx4 v[52:55], v6, s[40:43], s90 offen
    s_add_u32 s90, s90, 8192
    buffer_load_dwordx4 v[56:59], v6, s[40:43], s90 offen
    s_add_u32 s90, s90, 8192
    buffer_load_dwordx4 v[60:63], v6, s[40:43], s90 offen
    s_add_u32 s90, s90, 8192
    buffer_load_dwordx4 v[64:67], v6, s[40:43], s90 offen
    s_add_u32 s90, s90, 8192
    buffer_load_dwordx4 v[68:71], v6, s[40:43], s90 offen
    s_add_u32 s90, s90, 8192
    buffer_load_dwordx4 v[72:75], v6, s[40:43], s90 offen
    s_add_u32 s90, s90, 8192
    buffer_load_dwordx4 v[76:79], v6, s[40:43], s90 offen
    s_add_u32 s90, s90, 8192
    buffer_load_dwordx4 v[80:83], v6, s[40:43], s90 offen
    s_add_u32 s90, s90, 8192
    buffer_load_dwordx4 v[84:87], v6, s[40:43], s90 offen
    s_add_u32 s90, s90, 8192
    buffer_load_dwordx4 v[88:91], v6, s[40:43], s90 offen
    s_add_u32 s90, s90, 8192
    buffer_load_dwordx4 v[92:95], v6, s[40:43], s90 offen
    s_add_u32 s90, s90, 8192
    buffer_load_dwordx4 v[96:99], v6, s[40:43], s90 offen
    s_add_u32 s90, s90, 8192
    buffer_load_dwordx4 v[100:103], v6, s[40:43], s90 offen
    s_add_u32 s90, s90, 8192
    buffer_load_dwordx4 v[104:107], v6, s[40:43], s90 offen
    s_add_u32 s90, s90, 8192
    buffer_load_dwordx4 v[108:111], v6, s[40:43], s90 offen
    s_add_u32 s90, s90, 8192
    buffer_load_dwordx4 v[112:115], v6, s[40:43], s90 offen
    s_add_u32 s90, s90, 8192
    buffer_load_dwordx4 v[116:119], v6, s[40:43], s90 offen
    s_cmp_ge_u32 s82, 16
    s_cbranch_scc1 L_S1_nobar
    s_barrier
L_S1_nobar:
    v_and_b32 v10, 7, v3
    v_lshrrev_b32 v11, 1, v10
    v_and_b32 v12, 1, v10
    v_mov_b32 v13, 0x0c0c0100
    v_mov_b32 v14, 0x01000c0c
    v_cmp_eq_u32 vcc, 1, v12
    s_nop 1
    v_cndmask_b32 v13, v13, v14, vcc
    v_mov_b32 v14, 0x0c0c0c0c
    v_cmp_eq_u32 vcc, 0, v11
    s_nop 1
    v_cndmask_b32 v25, v14, v13, vcc
    v_cmp_eq_u32 vcc, 1, v11
    s_nop 1
    v_cndmask_b32 v26, v14, v13, vcc
    v_cmp_eq_u32 vcc, 2, v11
    s_nop 1
    v_cndmask_b32 v27, v14, v13, vcc
    v_cmp_eq_u32 vcc, 3, v11
    s_nop 1
    v_cndmask_b32 v28, v14, v13, vcc
    v_mov_b32 v13, 0x0c0c0302
    v_mov_b32 v14, 0x03020c0c
    v_cmp_eq_u32 vcc, 1, v12
    s_nop 1
    v_cndmask_b32 v13, v13, v14, vcc
    v_mov_b32 v14, 0x0c0c0c0c
    v_cmp_eq_u32 vcc, 0, v11
    s_nop 1
    v_cndmask_b32 v29, v14, v13, vcc
    v_cmp_eq_u32 vcc, 1, v11
    s_nop 1
    v_cndmask_b32 v30, v14, v13, vcc
    v_cmp_eq_u32 vcc, 2, v11
    s_nop 1
    v_cndmask_b32 v31, v14, v13, vcc
    v_cmp_eq_u32 vcc, 3, v11
    s_nop 1
    v_cndmask_b32 v32, v14, v13, vcc
    s_waitcnt vmcnt(18)
    v_mov_b32 v8, 0
    v_mov_b32 v9, 0
    v_lshlrev_b32 v10, 16, v16
    v_and_b32 v11, 0xffff0000, v16
    v_add_f32 v8, v8, v10
    v_fmac_f32 v9, v10, v10
    v_add_f32 v8, v8, v11
    v_fmac_f32 v9, v11, v11
    v_lshlrev_b32 v10, 16, v17
    v_and_b32 v11, 0xffff0000, v17
    v_add_f32 v8, v8, v10
    v_fmac_f32 v9, v10, v10
    v_add_f32 v8, v8, v11
    v_fmac_f32 v9, v11, v11
    v_lshlrev_b32 v10, 16, v18
    v_and_b32 v11, 0xffff0000, v18
    v_add_f32 v8, v8, v10
    v_fmac_f32 v9, v10, v10
    v_add_f32 v8, v8, v11
    v_fmac_f32 v9, v11, v11
    v_lshlrev_b32 v10, 16, v19
    v_and_b32 v11, 0xffff0000, v19
    v_add_f32 v8, v8, v10
    v_fmac_f32 v9, v10, v10
    v_add_f32 v8, v8, v11
    v_fmac_f32 v9, v11, v11
    v_lshlrev_b32 v10, 16, v20
    v_and_b32 v11, 0xffff0000, v20
    v_add_f32 v8, v8, v10
    v_fmac_f32 v9, v10, v10
    v_add_f32 v8, v8, v11
    v_fmac_f32 v9, v11, v11
    v_lshlrev_b32 v10, 16, v21
    v_and_b32 v11, 0xffff0000, v21
    v_add_f32 v8, v8, v10
    v_fmac_f32 v9, v10, v10
    v_add_f32 v8, v8, v11
    v_fmac_f32 v9, v11, v11
    v_lshlrev_b32 v10, 16, v22
    v_and_b32 v11, 0xffff0000, v22
    v_add_f32 v8, v8, v10
    v_fmac_f32 v9, v10, v10
    v_add_f32 v8, v8, v11
    v_fmac_f32 v9, v11, v11
    v_lshlrev_b32 v10, 16, v23
    v_and_b32 v11, 0xffff0000, v23
    v_add_f32 v8, v8, v10
    v_fmac_f32 v9, v10, v10
    v_add_f32 v8, v8, v11
    v_fmac_f32 v9, v11, v11
    v_lshlrev_b32 v10, 16, v24
    v_and_b32 v11, 0xffff0000, v24
    v_add_f32 v8, v8, v10
    v_fmac_f32 v9, v10, v10
    v_add_f32 v8, v8, v11
    v_fmac_f32 v9, v11, v11
    s_nop 0
    v_add_f32_dpp v8, v8, v8 row_ror:8 row_mask:0xf bank_mask:0xf
    s_nop 1
    v_add_f32_dpp v8, v8, v8 row_ror:4 row_mask:0xf bank_mask:0xf
    s_nop 1
    v_add_f32_dpp v8, v8, v8 row_ror:2 row_mask:0xf bank_mask:0xf
    s_nop 1
    v_add_f32_dpp v8, v8, v8 row_ror:1 row_mask:0xf bank_mask:0xf
    v_mov_b32 v10, v8
    s_nop 1
    v_permlane16_swap_b32 v8, v10
    v_add_f32 v8, v8, v10
    v_add_f32_dpp v9, v9, v9 row_ror:8 row_mask:0xf bank_mask:0xf
    s_nop 1
    v_add_f32_dpp v9, v9, v9 row_ror:4 row_mask:0xf bank_mask:0xf
    s_nop 1
    v_add_f32_dpp v9, v9, v9 row_ror:2 row_mask:0xf bank_mask:0xf
    s_nop 1
    v_add_f32_dpp v9, v9, v9 row_ror:1 row_mask:0xf bank_mask:0xf
    v_mov_b32 v10, v9
    s_nop 1
    v_permlane16_swap_b32 v9, v10
    v_add_f32 v9, v9, v10
    v_mul_f32 v8, 0x3ae38e39, v8
    v_mul_f32 v9, 0x3ae38e39, v9
    v_fma_f32 v9, -v8, v8, v9
    v_max_f32 v9, 0, v9
    v_add_f32 v9, 0x3727c5ac, v9
    v_rsq_f32 v9, v9
    s_mov_b32 s93, 0
    v_add_u32 v12, s93, v5
    v_lshlrev_b32 v10, 16, v16
    v_and_b32 v11, 0xffff0000, v16
    v_sub_f32 v10, v10, v8
    v_sub_f32 v11, v11, v8
    v_mul_f32 v10, v10, v9
    v_mul_f32 v11, v11, v9
    v_cvt_pk_bf16_f32 v10, v10, v11
    ds_write_b32 v12, v10 offset:0
    v_lshlrev_b32 v10, 16, v17
    v_and_b32 v11, 0xffff0000, v17
    v_sub_f32 v10, v10, v8
    v_sub_f32 v11, v11, v8
    v_mul_f32 v10, v10, v9
    v_mul_f32 v11, v11, v9
    v_cvt_pk_bf16_f32 v10, v10, v11
    ds_write_b32 v12, v10 offset:4
    v_lshlrev_b32 v10, 16, v18
    v_and_b32 v11, 0xffff0000, v18
    v_sub_f32 v10, v10, v8
    v_sub_f32 v11, v11, v8
    v_mul_f32 v10, v10, v9
    v_mul_f32 v11, v11, v9
    v_cvt_pk_bf16_f32 v10, v10, v11
    ds_write_b32 v12, v10 offset:8
    v_lshlrev_b32 v10, 16, v19
    v_and_b32 v11, 0xffff0000, v19
    v_sub_f32 v10, v10, v8
    v_sub_f32 v11, v11, v8
    v_mul_f32 v10, v10, v9
    v_mul_f32 v11, v11, v9
    v_cvt_pk_bf16_f32 v10, v10, v11
    ds_write_b32 v12, v10 offset:12
    v_lshlrev_b32 v10, 16, v20
    v_and_b32 v11, 0xffff0000, v20
    v_sub_f32 v10, v10, v8
    v_sub_f32 v11, v11, v8
    v_mul_f32 v10, v10, v9
    v_mul_f32 v11, v11, v9
    v_cvt_pk_bf16_f32 v10, v10, v11
    ds_write_b32 v12, v10 offset:16
    v_lshlrev_b32 v10, 16, v21
    v_and_b32 v11, 0xffff0000, v21
    v_sub_f32 v10, v10, v8
    v_sub_f32 v11, v11, v8
    v_mul_f32 v10, v10, v9
    v_mul_f32 v11, v11, v9
    v_cvt_pk_bf16_f32 v10, v10, v11
    ds_write_b32 v12, v10 offset:20
    v_lshlrev_b32 v10, 16, v22
    v_and_b32 v11, 0xffff0000, v22
    v_sub_f32 v10, v10, v8
    v_sub_f32 v11, v11, v8
    v_mul_f32 v10, v10, v9
    v_mul_f32 v11, v11, v9
    v_cvt_pk_bf16_f32 v10, v10, v11
    ds_write_b32 v12, v10 offset:24
    v_lshlrev_b32 v10, 16, v23
    v_and_b32 v11, 0xffff0000, v23
    v_sub_f32 v10, v10, v8
    v_sub_f32 v11, v11, v8
    v_mul_f32 v10, v10, v9
    v_mul_f32 v11, v11, v9
    v_cvt_pk_bf16_f32 v10, v10, v11
    ds_write_b32 v12, v10 offset:28
    v_lshlrev_b32 v10, 16, v24
    v_and_b32 v11, 0xffff0000, v24
    v_sub_f32 v10, v10, v8
    v_sub_f32 v11, v11, v8
    v_mul_f32 v10, v10, v9
    v_mul_f32 v11, v11, v9
    v_cvt_pk_bf16_f32 v10, v10, v11
    ds_write_b32 v12, v10 offset:32
    v_lshrrev_b32 v10, 3, v3
    v_mul_u32_u24 v10, 1152, v10
    v_mul_u32_u24 v11, 36, v4
    s_mul_i32 s90, s87, 144
    s_add_u32 s90, s90, s93
    v_add3_u32 v12, v10, v11, s90
    s_waitcnt lgkmcnt(0)
    ds_read_b32 v16, v12 offset:0
    ds_read_b32 v17, v12 offset:4
    ds_read_b32 v18, v12 offset:8
    ds_read_b32 v19, v12 offset:12
    ds_read_b32 v20, v12 offset:16
    ds_read_b32 v21, v12 offset:20
    ds_read_b32 v22, v12 offset:24
    ds_read_b32 v23, v12 offset:28
    ds_read_b32 v24, v12 offset:32
    v_mov_b32 v36, 0
    v_mov_b32 v37, 0
    v_mov_b32 v38, 0
    v_mov_b32 v39, 0
    v_lshrrev_b32 v10, 1, v4
    v_lshlrev_b32 v10, 5, v10
    v_lshl_add_u32 v10, v3, 1, v10
    v_and_b32 v11, 1, v4
    v_add_u32 v10, v10, v11
    v_lshlrev_b32 v7, 4, v10
    s_lshl_b32 s92, s86, 3
    s_add_u32 s92, s92, s87
    s_lshl_b32 s92, s92, 10
    s_waitcnt lgkmcnt(0)
    s_add_u32 s88, s0, 1
    s_and_b32 s88, s88, 0xbfffbfff
    s_and_b32 s89, s1, 0xbfffbfff
    s_waitcnt vmcnt(15)
    v_perm_b32 v40, v16, v16, v25
    v_perm_b32 v41, v16, v16, v26
    v_perm_b32 v42, v16, v16, v27
    v_perm_b32 v43, v16, v16, v28
    s_nop 1
    v_mfma_f32_16x16x32_bf16 v[36:39], v[40:43], v[48:51], v[36:39]
    v_perm_b32 v44, v16, v16, v29
    v_perm_b32 v45, v16, v16, v30
    v_perm_b32 v46, v16, v16, v31
    v_perm_b32 v47, v16, v16, v32
    s_nop 1
    v_mfma_f32_16x16x32_bf16 v[36:39], v[44:47], v[52:55], v[36:39]
    v_perm_b32 v40, v17, v17, v25
    v_perm_b32 v41, v17, v17, v26
    v_perm_b32 v42, v17, v17, v27
    v_perm_b32 v43, v17, v17, v28
    s_nop 1
    v_mfma_f32_16x16x32_bf16 v[36:39], v[40:43], v[56:59], v[36:39]
    s_waitcnt vmcnt(12)
    v_perm_b32 v44, v17, v17, v29
    v_perm_b32 v45, v17, v17, v30
    v_perm_b32 v46, v17, v17, v31
    v_perm_b32 v47, v17, v17, v32
    s_nop 1
    v_mfma_f32_16x16x32_bf16 v[36:39], v[44:47], v[60:63], v[36:39]
    v_perm_b32 v40, v18, v18, v25
    v_perm_b32 v41, v18, v18, v26
    v_perm_b32 v42, v18, v18, v27
    v_perm_b32 v43, v18, v18, v28
    s_nop 1
    v_mfma_f32_16x16x32_bf16 v[36:39], v[40:43], v[64:67], v[36:39]
    v_perm_b32 v44, v18, v18, v29
    v_perm_b32 v45, v18, v18, v30
    v_perm_b32 v46, v18, v18, v31
    v_perm_b32 v47, v18, v18, v32
    s_nop 1
    v_mfma_f32_16x16x32_bf16 v[36:39], v[44:47], v[68:71], v[36:39]
    s_waitcnt vmcnt(9)
    v_perm_b32 v40, v19, v19, v25
    v_perm_b32 v41, v19, v19, v26
    v_perm_b32 v42, v19, v19, v27
    v_perm_b32 v43, v19, v19, v28
    s_nop 1
    v_mfma_f32_16x16x32_bf16 v[36:39], v[40:43], v[72:75], v[36:39]
    v_perm_b32 v44, v19, v19, v29
    v_perm_b32 v45, v19, v19, v30
    v_perm_b32 v46, v19, v19, v31
    v_perm_b32 v47, v19, v19, v32
    s_nop 1
    v_mfma_f32_16x16x32_bf16 v[36:39], v[44:47], v[76:79], v[36:39]
    v_perm_b32 v40, v20, v20, v25
    v_perm_b32 v41, v20, v20, v26
    v_perm_b32 v42, v20, v20, v27
    v_perm_b32 v43, v20, v20, v28
    s_nop 1
    v_mfma_f32_16x16x32_bf16 v[36:39], v[40:43], v[80:83], v[36:39]
    s_waitcnt vmcnt(6)
    v_perm_b32 v44, v20, v20, v29
    v_perm_b32 v45, v20, v20, v30
    v_perm_b32 v46, v20, v20, v31
    v_perm_b32 v47, v20, v20, v32
    s_nop 1
    v_mfma_f32_16x16x32_bf16 v[36:39], v[44:47], v[84:87], v[36:39]
    v_perm_b32 v40, v21, v21, v25
    v_perm_b32 v41, v21, v21, v26
    v_perm_b32 v42, v21, v21, v27
    v_perm_b32 v43, v21, v21, v28
    s_nop 1
    v_mfma_f32_16x16x32_bf16 v[36:39], v[40:43], v[88:91], v[36:39]
    v_perm_b32 v44, v21, v21, v29
    v_perm_b32 v45, v21, v21, v30
    v_perm_b32 v46, v21, v21, v31
    v_perm_b32 v47, v21, v21, v32
    s_nop 1
    v_mfma_f32_16x16x32_bf16 v[36:39], v[44:47], v[92:95], v[36:39]
    s_waitcnt vmcnt(3)
    v_perm_b32 v40, v22, v22, v25
    v_perm_b32 v41, v22, v22, v26
    v_perm_b32 v42, v22, v22, v27
    v_perm_b32 v43, v22, v22, v28
    s_nop 1
    v_mfma_f32_16x16x32_bf16 v[36:39], v[40:43], v[96:99], v[36:39]
    v_perm_b32 v44, v22, v22, v29
    v_perm_b32 v45, v22, v22, v30
    v_perm_b32 v46, v22, v22, v31
    v_perm_b32 v47, v22, v22, v32
    s_nop 1
    v_mfma_f32_16x16x32_bf16 v[36:39], v[44:47], v[100:103], v[36:39]
    v_perm_b32 v40, v23, v23, v25
    v_perm_b32 v41, v23, v23, v26
    v_perm_b32 v42, v23, v23, v27
    v_perm_b32 v43, v23, v23, v28
    s_nop 1
    v_mfma_f32_16x16x32_bf16 v[36:39], v[40:43], v[104:107], v[36:39]
    s_waitcnt vmcnt(0)
    v_perm_b32 v44, v23, v23, v29
    v_perm_b32 v45, v23, v23, v30
    v_perm_b32 v46, v23, v23, v31
    v_perm_b32 v47, v23, v23, v32
    s_nop 1
    v_mfma_f32_16x16x32_bf16 v[36:39], v[44:47], v[108:111], v[36:39]
    v_perm_b32 v40, v24, v24, v25
    v_perm_b32 v41, v24, v24, v26
    v_perm_b32 v42, v24, v24, v27
    v_perm_b32 v43, v24, v24, v28
    s_nop 1
    v_mfma_f32_16x16x32_bf16 v[36:39], v[40:43], v[112:115], v[36:39]
    v_perm_b32 v44, v24, v24, v29
    v_perm_b32 v45, v24, v24, v30
    v_perm_b32 v46, v24, v24, v31
    v_perm_b32 v47, v24, v24, v32
    s_nop 1
    v_mfma_f32_16x16x32_bf16 v[36:39], v[44:47], v[116:119], v[36:39]
    s_nop 7
    v_cvt_pk_bf16_f32 v44, v36, v37
    v_cvt_pk_bf16_f32 v45, v38, v39
    v_mov_b32 v46, s88
    v_mov_b32 v47, s89
    buffer_store_dwordx4 v[44:47], v7, s[76:79], s92 offen offset:0 sc1
    s_cmp_ge_u32 s82, 16
    s_cbranch_scc1 L_X0_afterS1
    s_branch L_Y1_skip
L_Y1_pre:
    s_barrier
L_Y1_skip:
    s_waitcnt lgkmcnt(0)
    s_add_u32 s88, s0, 1
    s_and_b32 s88, s88, 0xbfffbfff
    s_and_b32 s89, s1, 0xbfffbfff
    s_barrier
    v_lshlrev_b32 v7, 15, v4
    v_lshl_add_u32 v7, v3, 4, v7
    s_mul_i32 s90, s84, 524288
    s_lshl_b32 s91, s83, 8
    s_add_u32 s90, s90, s91
    s_add_u32 s92, s90, 0
    buffer_load_dwordx4 v[104:107], v7, s[48:51], s92 offen
    s_add_u32 s92, s90, 131072
    buffer_load_dwordx4 v[108:111], v7, s[48:51], s92 offen
    s_add_u32 s92, s90, 262144
    buffer_load_dwordx4 v[112:115], v7, s[48:51], s92 offen
    s_add_u32 s92, s90, 393216
    buffer_load_dwordx4 v[116:119], v7, s[48:51], s92 offen
    s_add_u32 s92, s90, 8192
    buffer_load_dwordx4 v[120:123], v7, s[48:51], s92 offen
    s_add_u32 s92, s90, 139264
    buffer_load_dwordx4 v[124:127], v7, s[48:51], s92 offen
    s_add_u32 s92, s90, 270336
    buffer_load_dwordx4 v[128:131], v7, s[48:51], s92 offen
    s_add_u32 s92, s90, 401408
    buffer_load_dwordx4 v[132:135], v7, s[48:51], s92 offen
    s_add_u32 s92, s90, 16384
    buffer_load_dwordx4 v[136:139], v7, s[48:51], s92 offen
    s_add_u32 s92, s90, 147456
    buffer_load_dwordx4 v[140:143], v7, s[48:51], s92 offen
    s_add_u32 s92, s90, 278528
    buffer_load_dwordx4 v[144:147], v7, s[48:51], s92 offen
    s_add_u32 s92, s90, 409600
    buffer_load_dwordx4 v[148:151], v7, s[48:51], s92 offen
    s_add_u32 s92, s90, 24576
    buffer_load_dwordx4 v[152:155], v7, s[48:51], s92 offen
    s_add_u32 s92, s90, 155648
    buffer_load_dwordx4 v[156:159], v7, s[48:51], s92 offen
    s_add_u32 s92, s90, 286720
    buffer_load_dwordx4 v[160:163], v7, s[48:51], s92 offen
    s_add_u32 s92, s90, 417792
    buffer_load_dwordx4 v[164:167], v7, s[48:51], s92 offen
    v_and_b32 v10, 7, v3
    v_lshrrev_b32 v11, 1, v10
    v_and_b32 v12, 1, v10
    v_mov_b32 v13, 0x0c0c0100
    v_mov_b32 v14, 0x01000c0c
    v_cmp_eq_u32 vcc, 1, v12
    s_nop 1
    v_cndmask_b32 v13, v13, v14, vcc
    v_mov_b32 v14, 0x0c0c0c0c
    v_cmp_eq_u32 vcc, 0, v11
    s_nop 1
    v_cndmask_b32 v16, v14, v13, vcc
    v_cmp_eq_u32 vcc, 1, v11
    s_nop 1
    v_cndmask_b32 v17, v14, v13, vcc
    v_cmp_eq_u32 vcc, 2, v11
    s_nop 1
    v_cndmask_b32 v18, v14, v13, vcc
    v_cmp_eq_u32 vcc, 3, v11
    s_nop 1
    v_cndmask_b32 v19, v14, v13, vcc
    v_mov_b32 v13, 0x0c0c0302
    v_mov_b32 v14, 0x03020c0c
    v_cmp_eq_u32 vcc, 1, v12
    s_nop 1
    v_cndmask_b32 v13, v13, v14, vcc
    v_mov_b32 v14, 0x0c0c0c0c
    v_cmp_eq_u32 vcc, 0, v11
    s_nop 1
    v_cndmask_b32 v20, v14, v13, vcc
    v_cmp_eq_u32 vcc, 1, v11
    s_nop 1
    v_cndmask_b32 v21, v14, v13, vcc
    v_cmp_eq_u32 vcc, 2, v11
    s_nop 1
    v_cndmask_b32 v22, v14, v13, vcc
    v_cmp_eq_u32 vcc, 3, v11
    s_nop 1
    v_cndmask_b32 v23, v14, v13, vcc
    s_mov_b32 s28, 0x05040100
    s_mov_b32 s29, 0x07060302
    s_lshl_b32 s90, s83, 3
    s_add_u32 s90, s90, s84
    s_lshl_b32 s91, s90, 10
    s_add_u32 s91, s91, 524288
    s_lshl_b32 s95, s90, 13
    s_add_u32 s95, s95, 1048576
    v_lshlrev_b32 v5, 4, v2
    v_lshrrev_b32 v6, 3, v3
    v_lshlrev_b32 v6, 12, v6
    v_lshl_add_u32 v6, v4, 7, v6
    v_and_b32 v7, 7, v3
    v_lshl_add_u32 v6, v7, 4, v6
    s_waitcnt vmcnt(0)
    v_perm_b32 v40, v108, v104, s28
    v_perm_b32 v41, v116, v112, s28
    v_perm_b32 v42, v124, v120, s28
    v_perm_b32 v43, v132, v128, s28
    v_perm_b32 v44, v108, v104, s29
    v_perm_b32 v45, v116, v112, s29
    v_perm_b32 v46, v124, v120, s29
    v_perm_b32 v47, v132, v128, s29
    v_perm_b32 v48, v109, v105, s28
    v_perm_b32 v49, v117, v113, s28
    v_perm_b32 v50, v125, v121, s28
    v_perm_b32 v51, v133, v129, s28
    v_perm_b32 v52, v109, v105, s29
    v_perm_b32 v53, v117, v113, s29
    v_perm_b32 v54, v125, v121, s29
    v_perm_b32 v55, v133, v129, s29
    v_perm_b32 v56, v110, v106, s28
    v_perm_b32 v57, v118, v114, s28
    v_perm_b32 v58, v126, v122, s28
    v_perm_b32 v59, v134, v130, s28
    v_perm_b32 v60, v110, v106, s29
    v_perm_b32 v61, v118, v114, s29
    v_perm_b32 v62, v126, v122, s29
    v_perm_b32 v63, v134, v130, s29
    v_perm_b32 v64, v111, v107, s28
    v_perm_b32 v65, v119, v115, s28
    v_perm_b32 v66, v127, v123, s28
    v_perm_b32 v67, v135, v131, s28
    v_perm_b32 v68, v111, v107, s29
    v_perm_b32 v69, v119, v115, s29
    v_perm_b32 v70, v127, v123, s29
    v_perm_b32 v71, v135, v131, s29
    v_perm_b32 v72, v140, v136, s28
    v_perm_b32 v73, v148, v144, s28
    v_perm_b32 v74, v156, v152, s28
    v_perm_b32 v75, v164, v160, s28
    v_perm_b32 v76, v140, v136, s29
    v_perm_b32 v77, v148, v144, s29
    v_perm_b32 v78, v156, v152, s29
    v_perm_b32 v79, v164, v160, s29
    v_perm_b32 v80, v141, v137, s28
    v_perm_b32 v81, v149, v145, s28
    v_perm_b32 v82, v157, v153, s28
    v_perm_b32 v83, v165, v161, s28
    v_perm_b32 v84, v141, v137, s29
    v_perm_b32 v85, v149, v145, s29
    v_perm_b32 v86, v157, v153, s29
    v_perm_b32 v87, v165, v161, s29
    v_perm_b32 v88, v142, v138, s28
    v_perm_b32 v89, v150, v146, s28
    v_perm_b32 v90, v158, v154, s28
    v_perm_b32 v91, v166, v162, s28
    v_perm_b32 v92, v142, v138, s29
    v_perm_b32 v93, v150, v146, s29
    v_perm_b32 v94, v158, v154, s29
    v_perm_b32 v95, v166, v162, s29
    v_perm_b32 v96, v143, v139, s28
    v_perm_b32 v97, v151, v147, s28
    v_perm_b32 v98, v159, v155, s28
    v_perm_b32 v99, v167, v163, s28
    v_perm_b32 v100, v143, v139, s29
    v_perm_b32 v101, v151, v147, s29
    v_perm_b32 v102, v159, v155, s29
    v_perm_b32 v103, v167, v163, s29
    s_add_u32 s92, s30, s91
    s_addc_u32 s93, s31, 0
L_S4_sent:
    s_load_dwordx2 s[32:33], s[92:93], 120 glc
    s_load_dwordx2 s[34:35], s[92:93], 248 glc
    s_load_dwordx2 s[36:37], s[92:93], 376 glc
    s_load_dwordx2 s[38:39], s[92:93], 504 glc
    s_load_dwordx2 s[40:41], s[92:93], 632 glc
    s_load_dwordx2 s[42:43], s[92:93], 760 glc
    s_load_dwordx2 s[44:45], s[92:93], 888 glc
    s_load_dwordx2 s[46:47], s[92:93], 1016 glc
    s_waitcnt lgkmcnt(0)
    s_mov_b64 s[98:99], 0
    s_xor_b64 s[32:33], s[32:33], s[88:89]
    s_or_b64 s[98:99], s[98:99], s[32:33]
    s_xor_b64 s[34:35], s[34:35], s[88:89]
    s_or_b64 s[98:99], s[98:99], s[34:35]
    s_xor_b64 s[36:37], s[36:37], s[88:89]
    s_or_b64 s[98:99], s[98:99], s[36:37]
    s_xor_b64 s[38:39], s[38:39], s[88:89]
    s_or_b64 s[98:99], s[98:99], s[38:39]
    s_xor_b64 s[40:41], s[40:41], s[88:89]
    s_or_b64 s[98:99], s[98:99], s[40:41]
    s_xor_b64 s[42:43], s[42:43], s[88:89]
    s_or_b64 s[98:99], s[98:99], s[42:43]
    s_xor_b64 s[44:45], s[44:45], s[88:89]
    s_or_b64 s[98:99], s[98:99], s[44:45]
    s_xor_b64 s[46:47], s[46:47], s[88:89]
    s_or_b64 s[98:99], s[98:99], s[46:47]
    s_add_u32 s94, s94, 1
    s_cmp_gt_u32 s94, 400000
    s_cbranch_scc1 L_fin
    s_cmp_eq_u64 s[98:99], 0
    s_cbranch_scc1 L_S4_sent_ok
    s_sleep 4
    s_branch L_S4_sent
L_S4_sent_ok:
L_S4_poll:
    buffer_load_dwordx4 v[24:27], v5, s[76:79], s91 offen sc1
    s_waitcnt vmcnt(0)
    s_mov_b64 s[98:99], 0
    v_cmp_ne_u64 vcc, s[88:89], v[26:27]
    s_or_b64 s[98:99], s[98:99], vcc
    s_add_u32 s94, s94, 1
    s_cmp_gt_u32 s94, 400000
    s_cbranch_scc1 L_fin
    s_cmp_lg_u64 s[98:99], 0
    s_cbranch_scc1 L_S4_poll
    buffer_load_dwordx4 v[104:107], v6, s[76:79], s95 offen offset:0 sc1
    buffer_load_dwordx4 v[108:111], v6, s[76:79], s95 offen offset:512 sc1
    buffer_load_dwordx4 v[112:115], v6, s[76:79], s95 offen offset:1024 sc1
    buffer_load_dwordx4 v[116:119], v6, s[76:79], s95 offen offset:1536 sc1
    buffer_load_dwordx4 v[120:123], v6, s[76:79], s95 offen offset:2048 sc1
    buffer_load_dwordx4 v[124:127], v6, s[76:79], s95 offen offset:2560 sc1
    buffer_load_dwordx4 v[128:131], v6, s[76:79], s95 offen offset:3072 sc1
    buffer_load_dwordx4 v[132:135], v6, s[76:79], s95 offen offset:3584 sc1
    v_mov_b32 v6, v24
    s_nop 1
    v_max_f32_dpp v6, v6, v6 row_ror:8 row_mask:0xf bank_mask:0xf
    s_nop 1
    v_max_f32_dpp v6, v6, v6 row_ror:4 row_mask:0xf bank_mask:0xf
    s_nop 1
    v_max_f32_dpp v6, v6, v6 row_ror:2 row_mask:0xf bank_mask:0xf
    s_nop 1
    v_max_f32_dpp v6, v6, v6 row_ror:1 row_mask:0xf bank_mask:0xf
    v_mov_b32 v7, v6
    s_nop 1
    v_permlane16_swap_b32 v6, v7
    v_max_f32 v6, v6, v7
    v_sub_f32 v6, v24, v6
    v_exp_f32 v6, v6
    s_nop 0
    v_mul_f32 v7, v6, v25
    s_nop 1
    v_add_f32_dpp v7, v7, v7 row_ror:8 row_mask:0xf bank_mask:0xf
    s_nop 1
    v_add_f32_dpp v7, v7, v7 row_ror:4 row_mask:0xf bank_mask:0xf
    s_nop 1
    v_add_f32_dpp v7, v7, v7 row_ror:2 row_mask:0xf bank_mask:0xf
    s_nop 1
    v_add_f32_dpp v7, v7, v7 row_ror:1 row_mask:0xf bank_mask:0xf
    v_mov_b32 v36, v7
    s_nop 1
    v_permlane16_swap_b32 v7, v36
    v_add_f32 v7, v7, v36
    v_rcp_f32 v7, v7
    s_nop 0
    v_mul_f32 v6, v6, v7
    v_cvt_pk_bf16_f32 v6, v6, v6
    s_lshl_b32 s93, s80, 7
    s_add_u32 s93, s93, 9216
    v_lshrrev_b32 v7, 5, v2
    v_lshlrev_b32 v7, 6, v7
    v_and_b32 v36, 3, v2
    v_lshl_add_u32 v7, v36, 4, v7
    v_bfe_u32 v36, v2, 2, 3
    v_lshl_add_u32 v7, v36, 1, v7
    v_add_u32 v7, s93, v7
    ds_write_b16 v7, v6
    v_lshrrev_b32 v7, 3, v3
    v_lshlrev_b32 v7, 6, v7
    v_lshl_add_u32 v7, v4, 4, v7
    v_add_u32 v7, s93, v7
    s_waitcnt lgkmcnt(0)
    ds_read_b128 v[28:31], v7
    v_mov_b32 v36, 0
    v_mov_b32 v37, 0
    v_mov_b32 v38, 0
    v_mov_b32 v39, 0
    s_waitcnt lgkmcnt(0)
    s_waitcnt vmcnt(6)
    v_perm_b32 v8, v28, v28, v16
    v_perm_b32 v9, v28, v28, v17
    v_perm_b32 v10, v28, v28, v18
    v_perm_b32 v11, v28, v28, v19
    s_nop 1
    v_mfma_f32_16x16x32_bf16 v[36:39], v[8:11], v[104:107], v[36:39]
    v_perm_b32 v12, v28, v28, v20
    v_perm_b32 v13, v28, v28, v21
    v_perm_b32 v14, v28, v28, v22
    v_perm_b32 v15, v28, v28, v23
    s_nop 1
    v_mfma_f32_16x16x32_bf16 v[36:39], v[12:15], v[108:111], v[36:39]
    s_waitcnt vmcnt(4)
    v_perm_b32 v8, v29, v29, v16
    v_perm_b32 v9, v29, v29, v17
    v_perm_b32 v10, v29, v29, v18
    v_perm_b32 v11, v29, v29, v19
    s_nop 1
    v_mfma_f32_16x16x32_bf16 v[36:39], v[8:11], v[112:115], v[36:39]
    v_perm_b32 v12, v29, v29, v20
    v_perm_b32 v13, v29, v29, v21
    v_perm_b32 v14, v29, v29, v22
    v_perm_b32 v15, v29, v29, v23
    s_nop 1
    v_mfma_f32_16x16x32_bf16 v[36:39], v[12:15], v[116:119], v[36:39]
    s_waitcnt vmcnt(2)
    v_perm_b32 v8, v30, v30, v16
    v_perm_b32 v9, v30, v30, v17
    v_perm_b32 v10, v30, v30, v18
    v_perm_b32 v11, v30, v30, v19
    s_nop 1
    v_mfma_f32_16x16x32_bf16 v[36:39], v[8:11], v[120:123], v[36:39]
    v_perm_b32 v12, v30, v30, v20
    v_perm_b32 v13, v30, v30, v21
    v_perm_b32 v14, v30, v30, v22
    v_perm_b32 v15, v30, v30, v23
    s_nop 1
    v_mfma_f32_16x16x32_bf16 v[36:39], v[12:15], v[124:127], v[36:39]
    s_waitcnt vmcnt(0)
    v_perm_b32 v8, v31, v31, v16
    v_perm_b32 v9, v31, v31, v17
    v_perm_b32 v10, v31, v31, v18
    v_perm_b32 v11, v31, v31, v19
    s_nop 1
    v_mfma_f32_16x16x32_bf16 v[36:39], v[8:11], v[128:131], v[36:39]
    v_perm_b32 v12, v31, v31, v20
    v_perm_b32 v13, v31, v31, v21
    v_perm_b32 v14, v31, v31, v22
    v_perm_b32 v15, v31, v31, v23
    s_nop 1
    v_mfma_f32_16x16x32_bf16 v[36:39], v[12:15], v[132:135], v[36:39]
    s_nop 7
    v_cvt_pk_bf16_f32 v6, v36, v37
    v_cvt_pk_bf16_f32 v7, v38, v39
    s_lshl_b32 s93, s80, 8
    s_add_u32 s93, s93, 9728
    v_lshrrev_b32 v28, 3, v3
    v_lshrrev_b32 v29, 1, v4
    v_lshlrev_b32 v30, 7, v28
    v_and_b32 v31, 7, v3
    v_lshl_add_u32 v30, v31, 4, v30
    v_and_b32 v31, 1, v4
    v_lshl_add_u32 v30, v31, 3, v30
    v_add_u32 v30, s93, v30
    v_cmp_eq_u32 vcc, v28, v29
    s_and_saveexec_b64 s[96:97], vcc
    ds_write_b64 v30, v[6:7]
    s_mov_b64 exec, s[96:97]
    v_bfe_u32 v28, v3, 2, 1
    v_lshlrev_b32 v28, 7, v28
    v_lshl_add_u32 v28, v4, 5, v28
    v_add_u32 v28, s93, v28
    s_waitcnt lgkmcnt(0)
    ds_read_b128 v[8:11], v28
    ds_read_b128 v[12:15], v28 offset:16
    v_mov_b32 v104, 0
    v_mov_b32 v105, 0
    v_mov_b32 v106, 0
    v_mov_b32 v107, 0
    v_mov_b32 v108, 0
    v_mov_b32 v109, 0
    v_mov_b32 v110, 0
    v_mov_b32 v111, 0
    v_mov_b32 v112, 0
    v_mov_b32 v113, 0
    v_mov_b32 v114, 0
    v_mov_b32 v115, 0
    v_mov_b32 v116, 0
    v_mov_b32 v117, 0
    v_mov_b32 v118, 0
    v_mov_b32 v119, 0
    v_mov_b32 v120, 0
    v_mov_b32 v121, 0
    v_mov_b32 v122, 0
    v_mov_b32 v123, 0
    v_mov_b32 v124, 0
    v_mov_b32 v125, 0
    v_mov_b32 v126, 0
    v_mov_b32 v127, 0
    v_mov_b32 v128, 0
    v_mov_b32 v129, 0
    v_mov_b32 v130, 0
    v_mov_b32 v131, 0
    v_mov_b32 v132, 0
    v_mov_b32 v133, 0
    v_mov_b32 v134, 0
    v_mov_b32 v135, 0
    s_waitcnt lgkmcnt(0)
    v_mfma_f32_16x16x32_bf16 v[104:107], v[8:11], v[40:43], v[104:107]
    v_mfma_f32_16x16x32_bf16 v[108:111], v[8:11], v[44:47], v[108:111]
    v_mfma_f32_16x16x32_bf16 v[112:115], v[8:11], v[48:51], v[112:115]
    v_mfma_f32_16x16x32_bf16 v[116:119], v[8:11], v[52:55], v[116:119]
    v_mfma_f32_16x16x32_bf16 v[120:123], v[8:11], v[56:59], v[120:123]
    v_mfma_f32_16x16x32_bf16 v[124:127], v[8:11], v[60:63], v[124:127]
    v_mfma_f32_16x16x32_bf16 v[128:131], v[8:11], v[64:67], v[128:131]
    v_mfma_f32_16x16x32_bf16 v[132:135], v[8:11], v[68:71], v[132:135]
    v_mfma_f32_16x16x32_bf16 v[104:107], v[12:15], v[72:75], v[104:107]
    v_mfma_f32_16x16x32_bf16 v[108:111], v[12:15], v[76:79], v[108:111]
    v_mfma_f32_16x16x32_bf16 v[112:115], v[12:15], v[80:83], v[112:115]
    v_mfma_f32_16x16x32_bf16 v[116:119], v[12:15], v[84:87], v[116:119]
    v_mfma_f32_16x16x32_bf16 v[120:123], v[12:15], v[88:91], v[120:123]
    v_mfma_f32_16x16x32_bf16 v[124:127], v[12:15], v[92:95], v[124:127]
    v_mfma_f32_16x16x32_bf16 v[128:131], v[12:15], v[96:99], v[128:131]
    v_mfma_f32_16x16x32_bf16 v[132:135], v[12:15], v[100:103], v[132:135]
    v_lshlrev_b32 v5, 5, v2
    v_add_u32 v5, 10240, v5
    v_mov_b32 v16, v104
    v_mov_b32 v17, v108
    v_mov_b32 v18, v112
    v_mov_b32 v19, v116
    v_mov_b32 v20, v120
    v_mov_b32 v21, v124
    v_mov_b32 v22, v128
    v_mov_b32 v23, v132
    s_cmp_eq_u32 s80, 0
    s_cbranch_scc1 L_Y0_merge
    v_cmp_gt_u32 vcc, 2, v4
    s_and_saveexec_b64 s[96:97], vcc
    ds_write_b128 v5, v[16:19]
    ds_write_b128 v5, v[20:23] offset:16
    s_mov_b64 exec, s[96:97]
    s_waitcnt lgkmcnt(0)
    s_barrier
    s_barrier
    s_branch L_fin
L_Y0_merge:
    s_barrier
    ds_read_b128 v[24:27], v5
    ds_read_b128 v[28:31], v5 offset:16
    v_lshlrev_b32 v8, 8, v4
    v_lshl_add_u32 v8, v3, 4, v8
    v_add_u32 v8, 12288, v8
    s_waitcnt lgkmcnt(0)
    v_add_f32 v16, v16, v24
    v_add_f32 v17, v17, v25
    v_add_f32 v18, v18, v26
    v_add_f32 v19, v19, v27
    v_add_f32 v20, v20, v28
    v_add_f32 v21, v21, v29
    v_add_f32 v22, v22, v30
    v_add_f32 v23, v23, v31
    v_cvt_pk_bf16_f32 v12, v16, v17
    v_cvt_pk_bf16_f32 v13, v18, v19
    v_cvt_pk_bf16_f32 v14, v20, v21
    v_cvt_pk_bf16_f32 v15, v22, v23
    v_cmp_gt_u32 vcc, 2, v4
    s_and_saveexec_b64 s[96:97], vcc
    ds_write_b128 v8, v[12:15]
    s_mov_b64 exec, s[96:97]
    s_waitcnt lgkmcnt(0)
    s_barrier
    s_branch L_fin
L_Y23:
    s_barrier
    v_lshlrev_b32 v7, 13, v3
    v_lshl_add_u32 v7, v4, 4, v7
    s_mul_i32 s90, s84, 524288
    s_lshl_b32 s91, s83, 8
    s_add_u32 s90, s90, s91
    buffer_load_dwordx4 v[52:55], v7, s[44:47], s90 offen offset:0
    buffer_load_dwordx4 v[56:59], v7, s[44:47], s90 offen offset:64
    buffer_load_dwordx4 v[60:63], v7, s[44:47], s90 offen offset:128
    buffer_load_dwordx4 v[64:67], v7, s[44:47], s90 offen offset:192
    s_add_u32 s90, s90, 131072
    buffer_load_dwordx4 v[68:71], v7, s[44:47], s90 offen offset:0
    buffer_load_dwordx4 v[72:75], v7, s[44:47], s90 offen offset:64
    buffer_load_dwordx4 v[76:79], v7, s[44:47], s90 offen offset:128
    buffer_load_dwordx4 v[80:83], v7, s[44:47], s90 offen offset:192
    s_add_u32 s90, s90, 131072
    buffer_load_dwordx4 v[84:87], v7, s[44:47], s90 offen offset:0
    buffer_load_dwordx4 v[88:91], v7, s[44:47], s90 offen offset:64
    buffer_load_dwordx4 v[92:95], v7, s[44:47], s90 offen offset:128
    buffer_load_dwordx4 v[96:99], v7, s[44:47], s90 offen offset:192
    s_add_u32 s90, s90, 131072
    buffer_load_dwordx4 v[100:103], v7, s[44:47], s90 offen offset:0
    buffer_load_dwordx4 v[104:107], v7, s[44:47], s90 offen offset:64
    buffer_load_dwordx4 v[108:111], v7, s[44:47], s90 offen offset:128
    buffer_load_dwordx4 v[112:115], v7, s[44:47], s90 offen offset:192
    v_and_b32 v10, 3, v3
    v_lshrrev_b32 v11, 2, v3
    v_mov_b32 v12, 0x3f80
    v_mov_b32 v13, 0x3f800000
    v_and_b32 v14, 1, v10
    v_cmp_eq_u32 vcc, 1, v14
    s_nop 1
    v_cndmask_b32 v12, v12, v13, vcc
    v_lshrrev_b32 v14, 1, v10
    v_lshl_add_u32 v15, v11, 1, v14
    v_cmp_eq_u32 vcc, 0, v15
    s_nop 1
    v_cndmask_b32 v16, 0, v12, vcc
    v_cmp_eq_u32 vcc, 1, v15
    s_nop 1
    v_cndmask_b32 v17, 0, v12, vcc
    v_mov_b32 v18, 0
    v_mov_b32 v19, 0
    v_cmp_eq_u32 vcc, 2, v15
    s_nop 1
    v_cndmask_b32 v20, 0, v12, vcc
    v_cmp_eq_u32 vcc, 3, v15
    s_nop 1
    v_cndmask_b32 v21, 0, v12, vcc
    v_mov_b32 v22, 0
    v_mov_b32 v23, 0
    v_cmp_eq_u32 vcc, 4, v15
    s_nop 1
    v_cndmask_b32 v24, 0, v12, vcc
    v_cmp_eq_u32 vcc, 5, v15
    s_nop 1
    v_cndmask_b32 v25, 0, v12, vcc
    v_mov_b32 v26, 0
    v_mov_b32 v27, 0
    v_cmp_eq_u32 vcc, 6, v15
    s_nop 1
    v_cndmask_b32 v28, 0, v12, vcc
    v_cmp_eq_u32 vcc, 7, v15
    s_nop 1
    v_cndmask_b32 v29, 0, v12, vcc
    v_mov_b32 v30, 0
    v_mov_b32 v31, 0
    v_lshlrev_b32 v6, 10, v4
    v_lshl_add_u32 v6, v3, 4, v6
    s_lshl_b32 s92, s83, 13
    s_add_u32 s93, s92, 4096
    s_and_b32 s90, s80, 1
    s_lshl_b32 s90, s90, 9
    s_add_u32 s90, s90, 8192
    v_lshlrev_b32 v8, 3, v2
    v_add_u32 v8, s90, v8
    v_and_b32 v9, 1, v3
    v_lshlrev_b32 v9, 8, v9
    v_lshl_add_u32 v9, v4, 4, v9
    v_add_u32 v9, s90, v9
    s_lshl_b32 s90, s83, 11
    s_lshl_b32 s91, s84, 8
    s_add_u32 s90, s90, s91
    s_add_u32 s95, s90, 262144
    v_lshlrev_b32 v5, 16, v3
    v_lshl_add_u32 v5, v4, 4, v5
    s_waitcnt lgkmcnt(0)
    s_add_u32 s88, s0, 1
    s_and_b32 s88, s88, 0xbfffbfff
    s_and_b32 s89, s1, 0xbfffbfff
L_L1_poll:
    buffer_load_dwordx4 v[116:119], v6, s[76:79], s92 offen offset:0 sc1
    buffer_load_dwordx4 v[120:123], v6, s[76:79], s92 offen offset:256 sc1
    buffer_load_dwordx4 v[124:127], v6, s[76:79], s92 offen offset:512 sc1
    buffer_load_dwordx4 v[128:131], v6, s[76:79], s92 offen offset:768 sc1
    buffer_load_dwordx4 v[132:135], v6, s[76:79], s93 offen offset:0 sc1
    buffer_load_dwordx4 v[136:139], v6, s[76:79], s93 offen offset:256 sc1
    buffer_load_dwordx4 v[140:143], v6, s[76:79], s93 offen offset:512 sc1
    buffer_load_dwordx4 v[144:147], v6, s[76:79], s93 offen offset:768 sc1
    s_waitcnt vmcnt(0)
    s_mov_b64 s[98:99], 0
    v_cmp_ne_u64 vcc, s[88:89], v[118:119]
    s_or_b64 s[98:99], s[98:99], vcc
    v_cmp_ne_u64 vcc, s[88:89], v[122:123]
    s_or_b64 s[98:99], s[98:99], vcc
    v_cmp_ne_u64 vcc, s[88:89], v[126:127]
    s_or_b64 s[98:99], s[98:99], vcc
    v_cmp_ne_u64 vcc, s[88:89], v[130:131]
    s_or_b64 s[98:99], s[98:99], vcc
    v_cmp_ne_u64 vcc, s[88:89], v[134:135]
    s_or_b64 s[98:99], s[98:99], vcc
    v_cmp_ne_u64 vcc, s[88:89], v[138:139]
    s_or_b64 s[98:99], s[98:99], vcc
    v_cmp_ne_u64 vcc, s[88:89], v[142:143]
    s_or_b64 s[98:99], s[98:99], vcc
    v_cmp_ne_u64 vcc, s[88:89], v[146:147]
    s_or_b64 s[98:99], s[98:99], vcc
    s_add_u32 s94, s94, 1
    s_cmp_gt_u32 s94, 400000
    s_cbranch_scc1 L_fin
    s_cmp_lg_u64 s[98:99], 0
    s_cbranch_scc1 L_L1_poll
    v_mov_b32 v32, 0
    v_mov_b32 v33, 0
    v_mov_b32 v34, 0
    v_mov_b32 v35, 0
    s_nop 1
    v_mfma_f32_16x16x32_bf16 v[32:35], v[16:19], v[116:119], v[32:35]
    v_mfma_f32_16x16x32_bf16 v[32:35], v[20:23], v[120:123], v[32:35]
    v_mfma_f32_16x16x32_bf16 v[32:35], v[24:27], v[124:127], v[32:35]
    v_mfma_f32_16x16x32_bf16 v[32:35], v[28:31], v[128:131], v[32:35]
    v_mfma_f32_16x16x32_bf16 v[32:35], v[16:19], v[132:135], v[32:35]
    v_mfma_f32_16x16x32_bf16 v[32:35], v[20:23], v[136:139], v[32:35]
    v_mfma_f32_16x16x32_bf16 v[32:35], v[24:27], v[140:143], v[32:35]
    v_mfma_f32_16x16x32_bf16 v[32:35], v[28:31], v[144:147], v[32:35]
    s_nop 7
    v_cvt_pk_bf16_f32 v10, v32, v33
    v_cvt_pk_bf16_f32 v11, v34, v35
    ds_write_b64 v8, v[10:11]
    s_waitcnt lgkmcnt(0)
    ds_read_b128 v[36:39], v9 offset:0
    ds_read_b128 v[40:43], v9 offset:64
    ds_read_b128 v[44:47], v9 offset:128
    ds_read_b128 v[48:51], v9 offset:192
    v_mov_b32 v148, 0
    v_mov_b32 v149, 0
    v_mov_b32 v150, 0
    v_mov_b32 v151, 0
    v_mov_b32 v152, 0
    v_mov_b32 v153, 0
    v_mov_b32 v154, 0
    v_mov_b32 v155, 0
    v_mov_b32 v156, 0
    v_mov_b32 v157, 0
    v_mov_b32 v158, 0
    v_mov_b32 v159, 0
    v_mov_b32 v160, 0
    v_mov_b32 v161, 0
    v_mov_b32 v162, 0
    v_mov_b32 v163, 0
    s_waitcnt lgkmcnt(0)
    v_mfma_f32_16x16x32_bf16 v[148:151], v[52:55], v[36:39], v[148:151]
    v_mfma_f32_16x16x32_bf16 v[148:151], v[56:59], v[40:43], v[148:151]
    v_mfma_f32_16x16x32_bf16 v[148:151], v[60:63], v[44:47], v[148:151]
    v_mfma_f32_16x16x32_bf16 v[148:151], v[64:67], v[48:51], v[148:151]
    v_mfma_f32_16x16x32_bf16 v[152:155], v[68:71], v[36:39], v[152:155]
    v_mfma_f32_16x16x32_bf16 v[152:155], v[72:75], v[40:43], v[152:155]
    v_mfma_f32_16x16x32_bf16 v[152:155], v[76:79], v[44:47], v[152:155]
    v_mfma_f32_16x16x32_bf16 v[152:155], v[80:83], v[48:51], v[152:155]
    v_mfma_f32_16x16x32_bf16 v[156:159], v[84:87], v[36:39], v[156:159]
    v_mfma_f32_16x16x32_bf16 v[156:159], v[88:91], v[40:43], v[156:159]
    v_mfma_f32_16x16x32_bf16 v[156:159], v[92:95], v[44:47], v[156:159]
    v_mfma_f32_16x16x32_bf16 v[156:159], v[96:99], v[48:51], v[156:159]
    v_mfma_f32_16x16x32_bf16 v[160:163], v[100:103], v[36:39], v[160:163]
    v_mfma_f32_16x16x32_bf16 v[160:163], v[104:107], v[40:43], v[160:163]
    v_mfma_f32_16x16x32_bf16 v[160:163], v[108:111], v[44:47], v[160:163]
    v_mfma_f32_16x16x32_bf16 v[160:163], v[112:115], v[48:51], v[160:163]
    v_cmp_gt_u32 vcc, 2, v3
    s_and_saveexec_b64 s[96:97], vcc
    v_cvt_pk_bf16_f32 v116, v148, v149
    v_cvt_pk_bf16_f32 v117, v150, v151
    v_mov_b32 v118, s88
    v_mov_b32 v119, s89
    buffer_store_dwordx4 v[116:119], v5, s[76:79], s95 offen offset:0 sc1
    v_cvt_pk_bf16_f32 v120, v152, v153
    v_cvt_pk_bf16_f32 v121, v154, v155
    v_mov_b32 v122, s88
    v_mov_b32 v123, s89
    buffer_store_dwordx4 v[120:123], v5, s[76:79], s95 offen offset:64 sc1
    v_cvt_pk_bf16_f32 v124, v156, v157
    v_cvt_pk_bf16_f32 v125, v158, v159
    v_mov_b32 v126, s88
    v_mov_b32 v127, s89
    buffer_store_dwordx4 v[124:127], v5, s[76:79], s95 offen offset:128 sc1
    v_cvt_pk_bf16_f32 v128, v160, v161
    v_cvt_pk_bf16_f32 v129, v162, v163
    v_mov_b32 v130, s88
    v_mov_b32 v131, s89
    buffer_store_dwordx4 v[128:131], v5, s[76:79], s95 offen offset:192 sc1
    s_mov_b64 exec, s[96:97]
    s_barrier
    s_cmp_eq_u32 s80, 2
    s_cbranch_scc1 L_Y2_tile8
    s_barrier
    s_barrier
    s_lshl_b32 s86, s81, 4
    s_add_u32 s86, s86, s82
    s_cmp_ge_u32 s86, 72
    s_cbranch_scc1 L_fin
    v_and_b32 v10, 3, v3
    v_lshrrev_b32 v11, 2, v3
    v_mov_b32 v12, 0x3f80
    v_mov_b32 v13, 0x3f800000
    v_and_b32 v14, 1, v10
    v_cmp_eq_u32 vcc, 1, v14
    s_nop 1
    v_cndmask_b32 v12, v12, v13, vcc
    v_lshrrev_b32 v14, 1, v10
    v_lshl_add_u32 v15, v11, 1, v14
    v_cmp_eq_u32 vcc, 0, v15
    s_nop 1
    v_cndmask_b32 v16, 0, v12, vcc
    v_cmp_eq_u32 vcc, 1, v15
    s_nop 1
    v_cndmask_b32 v17, 0, v12, vcc
    v_mov_b32 v18, 0
    v_mov_b32 v19, 0
    s_lshl_b32 s87, s86, 5
    v_lshlrev_b32 v6, 3, v3
    v_mov_b32 v24, 0
    v_mov_b32 v25, 0
    v_cmp_gt_u32 vcc, 4, v2
    s_and_saveexec_b64 s[96:97], vcc
    buffer_load_dwordx2 v[24:25], v6, s[32:35], s87 offen
    s_waitcnt vmcnt(0)
    s_mov_b64 exec, s[96:97]
    v_lshlrev_b32 v20, 16, v24
    v_and_b32 v21, 0xffff0000, v24
    v_lshlrev_b32 v22, 16, v25
    v_and_b32 v23, 0xffff0000, v25
    v_lshlrev_b32 v5, 4, v2
    s_lshl_b32 s90, s86, 13
    s_add_u32 s90, s90, 3145728
    s_add_u32 s91, s90, 4096
L_R4_poll:
    buffer_load_dwordx4 v[32:35], v5, s[76:79], s90 offen offset:0 sc1
    buffer_load_dwordx4 v[36:39], v5, s[76:79], s90 offen offset:1024 sc1
    buffer_load_dwordx4 v[40:43], v5, s[76:79], s90 offen offset:2048 sc1
    buffer_load_dwordx4 v[44:47], v5, s[76:79], s90 offen offset:3072 sc1
    buffer_load_dwordx4 v[48:51], v5, s[76:79], s91 offen offset:0 sc1
    buffer_load_dwordx4 v[52:55], v5, s[76:79], s91 offen offset:1024 sc1
    buffer_load_dwordx4 v[56:59], v5, s[76:79], s91 offen offset:2048 sc1
    buffer_load_dwordx4 v[60:63], v5, s[76:79], s91 offen offset:3072 sc1
    s_waitcnt vmcnt(0)
    s_mov_b64 s[98:99], 0
    v_cmp_ne_u64 vcc, s[88:89], v[34:35]
    s_or_b64 s[98:99], s[98:99], vcc
    v_cmp_ne_u64 vcc, s[88:89], v[38:39]
    s_or_b64 s[98:99], s[98:99], vcc
    v_cmp_ne_u64 vcc, s[88:89], v[42:43]
    s_or_b64 s[98:99], s[98:99], vcc
    v_cmp_ne_u64 vcc, s[88:89], v[46:47]
    s_or_b64 s[98:99], s[98:99], vcc
    v_cmp_ne_u64 vcc, s[88:89], v[50:51]
    s_or_b64 s[98:99], s[98:99], vcc
    v_cmp_ne_u64 vcc, s[88:89], v[54:55]
    s_or_b64 s[98:99], s[98:99], vcc
    v_cmp_ne_u64 vcc, s[88:89], v[58:59]
    s_or_b64 s[98:99], s[98:99], vcc
    v_cmp_ne_u64 vcc, s[88:89], v[62:63]
    s_or_b64 s[98:99], s[98:99], vcc
    s_add_u32 s94, s94, 1
    s_cmp_gt_u32 s94, 400000
    s_cbranch_scc1 L_fin
    s_cmp_lg_u64 s[98:99], 0
    s_cbranch_scc1 L_R4_poll
    v_mfma_f32_16x16x32_bf16 v[20:23], v[16:19], v[32:35], v[20:23]
    v_mfma_f32_16x16x32_bf16 v[20:23], v[16:19], v[36:39], v[20:23]
    v_mfma_f32_16x16x32_bf16 v[20:23], v[16:19], v[40:43], v[20:23]
    v_mfma_f32_16x16x32_bf16 v[20:23], v[16:19], v[44:47], v[20:23]
    v_mfma_f32_16x16x32_bf16 v[20:23], v[16:19], v[48:51], v[20:23]
    v_mfma_f32_16x16x32_bf16 v[20:23], v[16:19], v[52:55], v[20:23]
    v_mfma_f32_16x16x32_bf16 v[20:23], v[16:19], v[56:59], v[20:23]
    v_mfma_f32_16x16x32_bf16 v[20:23], v[16:19], v[60:63], v[20:23]
    s_nop 7
    v_add_f32_dpp v26, v20, v20 row_ror:4 row_mask:0xf bank_mask:0xf
    v_add_f32_dpp v27, v21, v21 row_ror:4 row_mask:0xf bank_mask:0xf
    v_add_f32_dpp v28, v22, v22 row_ror:4 row_mask:0xf bank_mask:0xf
    v_add_f32_dpp v29, v23, v23 row_ror:4 row_mask:0xf bank_mask:0xf
    v_add_f32_dpp v26, v26, v26 row_ror:8 row_mask:0xf bank_mask:0xf
    v_add_f32_dpp v27, v27, v27 row_ror:8 row_mask:0xf bank_mask:0xf
    v_add_f32_dpp v28, v28, v28 row_ror:8 row_mask:0xf bank_mask:0xf
    v_add_f32_dpp v29, v29, v29 row_ror:8 row_mask:0xf bank_mask:0xf
    v_cvt_pk_bf16_f32 v12, v26, v27
    v_cvt_pk_bf16_f32 v13, v28, v29
    v_mov_b32 v14, s88
    v_mov_b32 v15, s89
    v_lshrrev_b32 v10, 2, v3
    s_movk_i32 s91, 4608
    v_mul_u32_u24 v7, s91, v10
    v_and_b32 v10, 3, v3
    v_lshl_add_u32 v7, v10, 4, v7
    s_lshl_b32 s90, s86, 6
    s_add_u32 s90, s90, 6291456
    s_add_u32 s91, s90, 18432
    v_cmp_gt_u32 vcc, 16, v2
    s_and_saveexec_b64 s[96:97], vcc
    buffer_store_dwordx4 v[12:15], v7, s[76:79], s90 offen sc1
    buffer_store_dwordx4 v[12:15], v7, s[76:79], s91 offen sc1
    s_mov_b64 exec, s[96:97]
    v_cmp_gt_u32 vcc, 4, v2
    s_nop 1
    v_cndmask_b32 v20, 0, v26, vcc
    v_cndmask_b32 v21, 0, v27, vcc
    v_cndmask_b32 v22, 0, v28, vcc
    v_cndmask_b32 v23, 0, v29, vcc
    s_lshl_b32 s90, s86, 13
    s_add_u32 s90, s90, 7340032
    s_add_u32 s91, s90, 4096
    v_mov_b32 v48, 0
    v_mov_b32 v49, 0
    v_mov_b32 v50, s88
    v_mov_b32 v51, s89
    s_mov_b32 s95, s90
    s_add_u32 s92, s30, s95
    s_addc_u32 s93, s31, 0
L_R6_poll_s:
    s_load_dwordx2 s[40:41], s[92:93], 1096 glc
    s_load_dwordx2 s[42:43], s[92:93], 2248 glc
    s_load_dwordx2 s[44:45], s[92:93], 3400 glc
    s_load_dwordx2 s[46:47], s[92:93], 4552 glc
    s_waitcnt lgkmcnt(0)
    s_mov_b64 s[98:99], 0
    s_xor_b64 s[40:41], s[40:41], s[88:89]
    s_or_b64 s[98:99], s[98:99], s[40:41]
    s_xor_b64 s[42:43], s[42:43], s[88:89]
    s_or_b64 s[98:99], s[98:99], s[42:43]
    s_xor_b64 s[44:45], s[44:45], s[88:89]
    s_or_b64 s[98:99], s[98:99], s[44:45]
    s_xor_b64 s[46:47], s[46:47], s[88:89]
    s_or_b64 s[98:99], s[98:99], s[46:47]
    s_add_u32 s94, s94, 1
    s_cmp_gt_u32 s94, 400000
    s_cbranch_scc1 L_fin
    s_cmp_eq_u64 s[98:99], 0
    s_cbranch_scc1 L_R6_poll_s_ok
    s_sleep 4
    s_branch L_R6_poll_s
L_R6_poll_s_ok:
L_R6_poll:
    buffer_load_dwordx4 v[32:35], v5, s[76:79], s90 offen offset:0 sc1
    buffer_load_dwordx4 v[36:39], v5, s[76:79], s90 offen offset:1024 sc1
    buffer_load_dwordx4 v[40:43], v5, s[76:79], s90 offen offset:2048 sc1
    buffer_load_dwordx4 v[44:47], v5, s[76:79], s90 offen offset:3072 sc1
    v_cmp_gt_u32 vcc, 32, v2
    s_and_saveexec_b64 s[96:97], vcc
    buffer_load_dwordx4 v[48:51], v5, s[76:79], s91 offen sc1
    s_mov_b64 exec, s[96:97]
    s_waitcnt vmcnt(0)
    s_mov_b64 s[98:99], 0
    v_cmp_ne_u64 vcc, s[88:89], v[34:35]
    s_or_b64 s[98:99], s[98:99], vcc
    v_cmp_ne_u64 vcc, s[88:89], v[38:39]
    s_or_b64 s[98:99], s[98:99], vcc
    v_cmp_ne_u64 vcc, s[88:89], v[42:43]
    s_or_b64 s[98:99], s[98:99], vcc
    v_cmp_ne_u64 vcc, s[88:89], v[46:47]
    s_or_b64 s[98:99], s[98:99], vcc
    v_cmp_ne_u64 vcc, s[88:89], v[50:51]
    s_or_b64 s[98:99], s[98:99], vcc
    s_add_u32 s94, s94, 1
    s_cmp_gt_u32 s94, 400000
    s_cbranch_scc1 L_fin
    s_cmp_lg_u64 s[98:99], 0
    s_cbranch_scc1 L_R6_poll
    v_mfma_f32_16x16x32_bf16 v[20:23], v[16:19], v[32:35], v[20:23]
    v_mfma_f32_16x16x32_bf16 v[20:23], v[16:19], v[36:39], v[20:23]
    v_mfma_f32_16x16x32_bf16 v[20:23], v[16:19], v[40:43], v[20:23]
    v_mfma_f32_16x16x32_bf16 v[20:23], v[16:19], v[44:47], v[20:23]
    v_mfma_f32_16x16x32_bf16 v[20:23], v[16:19], v[48:51], v[20:23]
    s_nop 7
    v_add_f32_dpp v26, v20, v20 row_ror:4 row_mask:0xf bank_mask:0xf
    v_add_f32_dpp v27, v21, v21 row_ror:4 row_mask:0xf bank_mask:0xf
    v_add_f32_dpp v28, v22, v22 row_ror:4 row_mask:0xf bank_mask:0xf
    v_add_f32_dpp v29, v23, v23 row_ror:4 row_mask:0xf bank_mask:0xf
    v_add_f32_dpp v26, v26, v26 row_ror:8 row_mask:0xf bank_mask:0xf
    v_add_f32_dpp v27, v27, v27 row_ror:8 row_mask:0xf bank_mask:0xf
    v_add_f32_dpp v28, v28, v28 row_ror:8 row_mask:0xf bank_mask:0xf
    v_add_f32_dpp v29, v29, v29 row_ror:8 row_mask:0xf bank_mask:0xf
    v_cvt_pk_bf16_f32 v10, v26, v27
    v_cvt_pk_bf16_f32 v11, v28, v29
    v_cmp_gt_u32 vcc, 4, v2
    s_and_saveexec_b64 s[96:97], vcc
    buffer_store_dwordx2 v[10:11], v6, s[68:71], s87 offen
    s_mov_b64 exec, s[96:97]
    s_cmp_lg_u32 s86, 0
    s_cbranch_scc1 L_noepoch
    s_add_u32 s90, s0, 1
    v_mov_b32 v10, s90
    v_mov_b32 v11, s1
    v_mov_b32 v12, 10485760
    s_mov_b64 exec, 1
    buffer_store_dwordx2 v[10:11], v12, s[76:79], 0 offen
    s_mov_b64 exec, -1
L_noepoch:
    s_branch L_fin
L_Y2_tile8:
    s_movk_i32 s95, 8
    s_branch L_Ytile2
L_Ytile:
    s_sub_u32 s95, s80, 4
    s_waitcnt lgkmcnt(0)
    s_add_u32 s88, s0, 1
    s_and_b32 s88, s88, 0xbfffbfff
    s_and_b32 s89, s1, 0xbfffbfff
    s_barrier
    s_barrier
L_Ytile2:
    s_mov_b32 s90, 36864
    v_mul_u32_u24 v6, s90, v4
    v_lshl_add_u32 v6, v3, 3, v6
    s_mul_i32 s90, s83, 147456
    s_lshl_b32 s91, s95, 7
    s_add_u32 s90, s90, s91
    s_and_b32 s92, s82, 3
    s_cmp_eq_u32 s92, 0
    s_cbranch_scc0 L_wo_n0
    s_add_u32 s91, s90, 0
    buffer_load_dwordx2 v[20:21], v6, s[52:55], s91 offen
    buffer_load_dwordx2 v[22:23], v6, s[52:55], s91 offen offset:1152
    s_add_u32 s91, s90, 2304
    buffer_load_dwordx2 v[24:25], v6, s[52:55], s91 offen
    buffer_load_dwordx2 v[26:27], v6, s[52:55], s91 offen offset:1152
    s_add_u32 s91, s90, 4608
    buffer_load_dwordx2 v[28:29], v6, s[52:55], s91 offen
    buffer_load_dwordx2 v[30:31], v6, s[52:55], s91 offen offset:1152
    s_add_u32 s91, s90, 6912
    buffer_load_dwordx2 v[32:33], v6, s[52:55], s91 offen
    buffer_load_dwordx2 v[34:35], v6, s[52:55], s91 offen offset:1152
    s_add_u32 s91, s90, 9216
    buffer_load_dwordx2 v[36:37], v6, s[52:55], s91 offen
    buffer_load_dwordx2 v[38:39], v6, s[52:55], s91 offen offset:1152
    s_add_u32 s91, s90, 11520
    buffer_load_dwordx2 v[40:41], v6, s[52:55], s91 offen
    buffer_load_dwordx2 v[42:43], v6, s[52:55], s91 offen offset:1152
    s_add_u32 s91, s90, 13824
    buffer_load_dwordx2 v[44:45], v6, s[52:55], s91 offen
    buffer_load_dwordx2 v[46:47], v6, s[52:55], s91 offen offset:1152
    s_add_u32 s91, s90, 16128
    buffer_load_dwordx2 v[48:49], v6, s[52:55], s91 offen
    buffer_load_dwordx2 v[50:51], v6, s[52:55], s91 offen offset:1152
    s_add_u32 s91, s90, 18432
    buffer_load_dwordx2 v[52:53], v6, s[52:55], s91 offen
    buffer_load_dwordx2 v[54:55], v6, s[52:55], s91 offen offset:1152
    s_add_u32 s91, s90, 20736
    buffer_load_dwordx2 v[56:57], v6, s[52:55], s91 offen
    buffer_load_dwordx2 v[58:59], v6, s[52:55], s91 offen offset:1152
    s_add_u32 s91, s90, 23040
    buffer_load_dwordx2 v[60:61], v6, s[52:55], s91 offen
    buffer_load_dwordx2 v[62:63], v6, s[52:55], s91 offen offset:1152
    s_add_u32 s91, s90, 25344
    buffer_load_dwordx2 v[64:65], v6, s[52:55], s91 offen
    buffer_load_dwordx2 v[66:67], v6, s[52:55], s91 offen offset:1152
    s_add_u32 s91, s90, 27648
    buffer_load_dwordx2 v[68:69], v6, s[52:55], s91 offen
    buffer_load_dwordx2 v[70:71], v6, s[52:55], s91 offen offset:1152
    s_add_u32 s91, s90, 29952
    buffer_load_dwordx2 v[72:73], v6, s[52:55], s91 offen
    buffer_load_dwordx2 v[74:75], v6, s[52:55], s91 offen offset:1152
    s_add_u32 s91, s90, 32256
    buffer_load_dwordx2 v[76:77], v6, s[52:55], s91 offen
    buffer_load_dwordx2 v[78:79], v6, s[52:55], s91 offen offset:1152
    s_add_u32 s91, s90, 34560
    buffer_load_dwordx2 v[80:81], v6, s[52:55], s91 offen
    buffer_load_dwordx2 v[82:83], v6, s[52:55], s91 offen offset:1152
    s_branch L_wo_ld
L_wo_n0:
    s_cmp_eq_u32 s92, 1
    s_cbranch_scc0 L_wo_n1
    s_add_u32 s91, s90, 9216
    buffer_load_dwordx2 v[36:37], v6, s[52:55], s91 offen
    buffer_load_dwordx2 v[38:39], v6, s[52:55], s91 offen offset:1152
    s_add_u32 s91, s90, 11520
    buffer_load_dwordx2 v[40:41], v6, s[52:55], s91 offen
    buffer_load_dwordx2 v[42:43], v6, s[52:55], s91 offen offset:1152
    s_add_u32 s91, s90, 13824
    buffer_load_dwordx2 v[44:45], v6, s[52:55], s91 offen
    buffer_load_dwordx2 v[46:47], v6, s[52:55], s91 offen offset:1152
    s_add_u32 s91, s90, 16128
    buffer_load_dwordx2 v[48:49], v6, s[52:55], s91 offen
    buffer_load_dwordx2 v[50:51], v6, s[52:55], s91 offen offset:1152
    s_add_u32 s91, s90, 18432
    buffer_load_dwordx2 v[52:53], v6, s[52:55], s91 offen
    buffer_load_dwordx2 v[54:55], v6, s[52:55], s91 offen offset:1152
    s_add_u32 s91, s90, 20736
    buffer_load_dwordx2 v[56:57], v6, s[52:55], s91 offen
    buffer_load_dwordx2 v[58:59], v6, s[52:55], s91 offen offset:1152
    s_add_u32 s91, s90, 23040
    buffer_load_dwordx2 v[60:61], v6, s[52:55], s91 offen
    buffer_load_dwordx2 v[62:63], v6, s[52:55], s91 offen offset:1152
    s_add_u32 s91, s90, 25344
    buffer_load_dwordx2 v[64:65], v6, s[52:55], s91 offen
    buffer_load_dwordx2 v[66:67], v6, s[52:55], s91 offen offset:1152
    s_add_u32 s91, s90, 27648
    buffer_load_dwordx2 v[68:69], v6, s[52:55], s91 offen
    buffer_load_dwordx2 v[70:71], v6, s[52:55], s91 offen offset:1152
    s_add_u32 s91, s90, 29952
    buffer_load_dwordx2 v[72:73], v6, s[52:55], s91 offen
    buffer_load_dwordx2 v[74:75], v6, s[52:55], s91 offen offset:1152
    s_add_u32 s91, s90, 32256
    buffer_load_dwordx2 v[76:77], v6, s[52:55], s91 offen
    buffer_load_dwordx2 v[78:79], v6, s[52:55], s91 offen offset:1152
    s_add_u32 s91, s90, 34560
    buffer_load_dwordx2 v[80:81], v6, s[52:55], s91 offen
    buffer_load_dwordx2 v[82:83], v6, s[52:55], s91 offen offset:1152
    s_add_u32 s91, s90, 0
    buffer_load_dwordx2 v[20:21], v6, s[52:55], s91 offen
    buffer_load_dwordx2 v[22:23], v6, s[52:55], s91 offen offset:1152
    s_add_u32 s91, s90, 2304
    buffer_load_dwordx2 v[24:25], v6, s[52:55], s91 offen
    buffer_load_dwordx2 v[26:27], v6, s[52:55], s91 offen offset:1152
    s_add_u32 s91, s90, 4608
    buffer_load_dwordx2 v[28:29], v6, s[52:55], s91 offen
    buffer_load_dwordx2 v[30:31], v6, s[52:55], s91 offen offset:1152
    s_add_u32 s91, s90, 6912
    buffer_load_dwordx2 v[32:33], v6, s[52:55], s91 offen
    buffer_load_dwordx2 v[34:35], v6, s[52:55], s91 offen offset:1152
    s_branch L_wo_ld
L_wo_n1:
    s_cmp_eq_u32 s92, 2
    s_cbranch_scc0 L_wo_n2
    s_add_u32 s91, s90, 18432
    buffer_load_dwordx2 v[52:53], v6, s[52:55], s91 offen
    buffer_load_dwordx2 v[54:55], v6, s[52:55], s91 offen offset:1152
    s_add_u32 s91, s90, 20736
    buffer_load_dwordx2 v[56:57], v6, s[52:55], s91 offen
    buffer_load_dwordx2 v[58:59], v6, s[52:55], s91 offen offset:1152
    s_add_u32 s91, s90, 23040
    buffer_load_dwordx2 v[60:61], v6, s[52:55], s91 offen
    buffer_load_dwordx2 v[62:63], v6, s[52:55], s91 offen offset:1152
    s_add_u32 s91, s90, 25344
    buffer_load_dwordx2 v[64:65], v6, s[52:55], s91 offen
    buffer_load_dwordx2 v[66:67], v6, s[52:55], s91 offen offset:1152
    s_add_u32 s91, s90, 27648
    buffer_load_dwordx2 v[68:69], v6, s[52:55], s91 offen
    buffer_load_dwordx2 v[70:71], v6, s[52:55], s91 offen offset:1152
    s_add_u32 s91, s90, 29952
    buffer_load_dwordx2 v[72:73], v6, s[52:55], s91 offen
    buffer_load_dwordx2 v[74:75], v6, s[52:55], s91 offen offset:1152
    s_add_u32 s91, s90, 32256
    buffer_load_dwordx2 v[76:77], v6, s[52:55], s91 offen
    buffer_load_dwordx2 v[78:79], v6, s[52:55], s91 offen offset:1152
    s_add_u32 s91, s90, 34560
    buffer_load_dwordx2 v[80:81], v6, s[52:55], s91 offen
    buffer_load_dwordx2 v[82:83], v6, s[52:55], s91 offen offset:1152
    s_add_u32 s91, s90, 0
    buffer_load_dwordx2 v[20:21], v6, s[52:55], s91 offen
    buffer_load_dwordx2 v[22:23], v6, s[52:55], s91 offen offset:1152
    s_add_u32 s91, s90, 2304
    buffer_load_dwordx2 v[24:25], v6, s[52:55], s91 offen
    buffer_load_dwordx2 v[26:27], v6, s[52:55], s91 offen offset:1152
    s_add_u32 s91, s90, 4608
    buffer_load_dwordx2 v[28:29], v6, s[52:55], s91 offen
    buffer_load_dwordx2 v[30:31], v6, s[52:55], s91 offen offset:1152
    s_add_u32 s91, s90, 6912
    buffer_load_dwordx2 v[32:33], v6, s[52:55], s91 offen
    buffer_load_dwordx2 v[34:35], v6, s[52:55], s91 offen offset:1152
    s_add_u32 s91, s90, 9216
    buffer_load_dwordx2 v[36:37], v6, s[52:55], s91 offen
    buffer_load_dwordx2 v[38:39], v6, s[52:55], s91 offen offset:1152
    s_add_u32 s91, s90, 11520
    buffer_load_dwordx2 v[40:41], v6, s[52:55], s91 offen
    buffer_load_dwordx2 v[42:43], v6, s[52:55], s91 offen offset:1152
    s_add_u32 s91, s90, 13824
    buffer_load_dwordx2 v[44:45], v6, s[52:55], s91 offen
    buffer_load_dwordx2 v[46:47], v6, s[52:55], s91 offen offset:1152
    s_add_u32 s91, s90, 16128
    buffer_load_dwordx2 v[48:49], v6, s[52:55], s91 offen
    buffer_load_dwordx2 v[50:51], v6, s[52:55], s91 offen offset:1152
    s_branch L_wo_ld
L_wo_n2:
    s_cmp_eq_u32 s92, 3
    s_cbranch_scc0 L_wo_n3
    s_add_u32 s91, s90, 27648
    buffer_load_dwordx2 v[68:69], v6, s[52:55], s91 offen
    buffer_load_dwordx2 v[70:71], v6, s[52:55], s91 offen offset:1152
    s_add_u32 s91, s90, 29952
    buffer_load_dwordx2 v[72:73], v6, s[52:55], s91 offen
    buffer_load_dwordx2 v[74:75], v6, s[52:55], s91 offen offset:1152
    s_add_u32 s91, s90, 32256
    buffer_load_dwordx2 v[76:77], v6, s[52:55], s91 offen
    buffer_load_dwordx2 v[78:79], v6, s[52:55], s91 offen offset:1152
    s_add_u32 s91, s90, 34560
    buffer_load_dwordx2 v[80:81], v6, s[52:55], s91 offen
    buffer_load_dwordx2 v[82:83], v6, s[52:55], s91 offen offset:1152
    s_add_u32 s91, s90, 0
    buffer_load_dwordx2 v[20:21], v6, s[52:55], s91 offen
    buffer_load_dwordx2 v[22:23], v6, s[52:55], s91 offen offset:1152
    s_add_u32 s91, s90, 2304
    buffer_load_dwordx2 v[24:25], v6, s[52:55], s91 offen
    buffer_load_dwordx2 v[26:27], v6, s[52:55], s91 offen offset:1152
    s_add_u32 s91, s90, 4608
    buffer_load_dwordx2 v[28:29], v6, s[52:55], s91 offen
    buffer_load_dwordx2 v[30:31], v6, s[52:55], s91 offen offset:1152
    s_add_u32 s91, s90, 6912
    buffer_load_dwordx2 v[32:33], v6, s[52:55], s91 offen
    buffer_load_dwordx2 v[34:35], v6, s[52:55], s91 offen offset:1152
    s_add_u32 s91, s90, 9216
    buffer_load_dwordx2 v[36:37], v6, s[52:55], s91 offen
    buffer_load_dwordx2 v[38:39], v6, s[52:55], s91 offen offset:1152
    s_add_u32 s91, s90, 11520
    buffer_load_dwordx2 v[40:41], v6, s[52:55], s91 offen
    buffer_load_dwordx2 v[42:43], v6, s[52:55], s91 offen offset:1152
    s_add_u32 s91, s90, 13824
    buffer_load_dwordx2 v[44:45], v6, s[52:55], s91 offen
    buffer_load_dwordx2 v[46:47], v6, s[52:55], s91 offen offset:1152
    s_add_u32 s91, s90, 16128
    buffer_load_dwordx2 v[48:49], v6, s[52:55], s91 offen
    buffer_load_dwordx2 v[50:51], v6, s[52:55], s91 offen offset:1152
    s_add_u32 s91, s90, 18432
    buffer_load_dwordx2 v[52:53], v6, s[52:55], s91 offen
    buffer_load_dwordx2 v[54:55], v6, s[52:55], s91 offen offset:1152
    s_add_u32 s91, s90, 20736
    buffer_load_dwordx2 v[56:57], v6, s[52:55], s91 offen
    buffer_load_dwordx2 v[58:59], v6, s[52:55], s91 offen offset:1152
    s_add_u32 s91, s90, 23040
    buffer_load_dwordx2 v[60:61], v6, s[52:55], s91 offen
    buffer_load_dwordx2 v[62:63], v6, s[52:55], s91 offen offset:1152
    s_add_u32 s91, s90, 25344
    buffer_load_dwordx2 v[64:65], v6, s[52:55], s91 offen
    buffer_load_dwordx2 v[66:67], v6, s[52:55], s91 offen offset:1152
    s_branch L_wo_ld
L_wo_n3:
L_wo_ld:
    v_mul_u32_u24 v7, 144, v4
    v_add_u32 v7, v7, v3
    s_lshl_b32 s91, s95, 4
    v_add_u32 v7, s91, v7
    v_lshrrev_b32 v10, 2, v7
    v_and_b32 v11, 3, v7
    v_lshlrev_b32 v8, 13, v10
    v_lshl_add_u32 v8, v11, 4, v8
    v_bfe_u32 v10, v3, 2, 1
    v_lshlrev_b32 v5, 8, v10
    v_lshl_add_u32 v5, v4, 6, v5
    v_add_u32 v5, 12288, v5
    s_lshl_b32 s90, s81, 4
    s_add_u32 s90, s90, s82
    s_lshl_b32 s90, s90, 6
    s_add_u32 s90, s90, 3145728
    s_mov_b32 s28, 0x05040100
    s_mov_b32 s29, 0x07060302
    s_waitcnt vmcnt(0)
    v_perm_b32 v84, v22, v20, s28
    v_perm_b32 v85, v26, v24, s28
    v_perm_b32 v86, v30, v28, s28
    v_perm_b32 v87, v34, v32, s28
    v_perm_b32 v88, v22, v20, s29
    v_perm_b32 v89, v26, v24, s29
    v_perm_b32 v90, v30, v28, s29
    v_perm_b32 v91, v34, v32, s29
    v_perm_b32 v92, v23, v21, s28
    v_perm_b32 v93, v27, v25, s28
    v_perm_b32 v94, v31, v29, s28
    v_perm_b32 v95, v35, v33, s28
    v_perm_b32 v96, v23, v21, s29
    v_perm_b32 v97, v27, v25, s29
    v_perm_b32 v98, v31, v29, s29
    v_perm_b32 v99, v35, v33, s29
    v_perm_b32 v100, v38, v36, s28
    v_perm_b32 v101, v42, v40, s28
    v_perm_b32 v102, v46, v44, s28
    v_perm_b32 v103, v50, v48, s28
    v_perm_b32 v104, v38, v36, s29
    v_perm_b32 v105, v42, v40, s29
    v_perm_b32 v106, v46, v44, s29
    v_perm_b32 v107, v50, v48, s29
    v_perm_b32 v108, v39, v37, s28
    v_perm_b32 v109, v43, v41, s28
    v_perm_b32 v110, v47, v45, s28
    v_perm_b32 v111, v51, v49, s28
    v_perm_b32 v112, v39, v37, s29
    v_perm_b32 v113, v43, v41, s29
    v_perm_b32 v114, v47, v45, s29
    v_perm_b32 v115, v51, v49, s29
    v_perm_b32 v116, v54, v52, s28
    v_perm_b32 v117, v58, v56, s28
    v_perm_b32 v118, v62, v60, s28
    v_perm_b32 v119, v66, v64, s28
    v_perm_b32 v120, v54, v52, s29
    v_perm_b32 v121, v58, v56, s29
    v_perm_b32 v122, v62, v60, s29
    v_perm_b32 v123, v66, v64, s29
    v_perm_b32 v124, v55, v53, s28
    v_perm_b32 v125, v59, v57, s28
    v_perm_b32 v126, v63, v61, s28
    v_perm_b32 v127, v67, v65, s28
    v_perm_b32 v128, v55, v53, s29
    v_perm_b32 v129, v59, v57, s29
    v_perm_b32 v130, v63, v61, s29
    v_perm_b32 v131, v67, v65, s29
    v_perm_b32 v132, v70, v68, s28
    v_perm_b32 v133, v74, v72, s28
    v_perm_b32 v134, v78, v76, s28
    v_perm_b32 v135, v82, v80, s28
    v_perm_b32 v136, v70, v68, s29
    v_perm_b32 v137, v74, v72, s29
    v_perm_b32 v138, v78, v76, s29
    v_perm_b32 v139, v82, v80, s29
    v_perm_b32 v140, v71, v69, s28
    v_perm_b32 v141, v75, v73, s28
    v_perm_b32 v142, v79, v77, s28
    v_perm_b32 v143, v83, v81, s28
    v_perm_b32 v144, v71, v69, s29
    v_perm_b32 v145, v75, v73, s29
    v_perm_b32 v146, v79, v77, s29
    v_perm_b32 v147, v83, v81, s29
    v_mov_b32 v20, 0
    v_mov_b32 v21, 0
    v_mov_b32 v22, 0
    v_mov_b32 v23, 0
    v_mov_b32 v24, 0
    v_mov_b32 v25, 0
    v_mov_b32 v26, 0
    v_mov_b32 v27, 0
    v_mov_b32 v28, 0
    v_mov_b32 v29, 0
    v_mov_b32 v30, 0
    v_mov_b32 v31, 0
    v_mov_b32 v32, 0
    v_mov_b32 v33, 0
    v_mov_b32 v34, 0
    v_mov_b32 v35, 0
    s_barrier
    s_barrier
    ds_read_b128 v[148:151], v5 offset:0
    ds_read_b128 v[152:155], v5 offset:16
    ds_read_b128 v[156:159], v5 offset:32
    ds_read_b128 v[160:163], v5 offset:48
    s_waitcnt lgkmcnt(0)
    v_mfma_f32_16x16x32_bf16 v[20:23], v[148:151], v[84:87], v[20:23]
    v_mfma_f32_16x16x32_bf16 v[24:27], v[148:151], v[88:91], v[24:27]
    v_mfma_f32_16x16x32_bf16 v[28:31], v[148:151], v[92:95], v[28:31]
    v_mfma_f32_16x16x32_bf16 v[32:35], v[148:151], v[96:99], v[32:35]
    v_mfma_f32_16x16x32_bf16 v[20:23], v[152:155], v[100:103], v[20:23]
    v_mfma_f32_16x16x32_bf16 v[24:27], v[152:155], v[104:107], v[24:27]
    v_mfma_f32_16x16x32_bf16 v[28:31], v[152:155], v[108:111], v[28:31]
    v_mfma_f32_16x16x32_bf16 v[32:35], v[152:155], v[112:115], v[32:35]
    v_mfma_f32_16x16x32_bf16 v[20:23], v[156:159], v[116:119], v[20:23]
    v_mfma_f32_16x16x32_bf16 v[24:27], v[156:159], v[120:123], v[24:27]
    v_mfma_f32_16x16x32_bf16 v[28:31], v[156:159], v[124:127], v[28:31]
    v_mfma_f32_16x16x32_bf16 v[32:35], v[156:159], v[128:131], v[32:35]
    v_mfma_f32_16x16x32_bf16 v[20:23], v[160:163], v[132:135], v[20:23]
    v_mfma_f32_16x16x32_bf16 v[24:27], v[160:163], v[136:139], v[24:27]
    v_mfma_f32_16x16x32_bf16 v[28:31], v[160:163], v[140:143], v[28:31]
    v_mfma_f32_16x16x32_bf16 v[32:35], v[160:163], v[144:147], v[32:35]
    s_nop 5
    v_cvt_pk_bf16_f32 v164, v20, v24
    s_nop 0
    v_cvt_pk_bf16_f32 v165, v28, v32
    v_mov_b32 v166, s88
    v_mov_b32 v167, s89
    v_cmp_gt_u32 vcc, 2, v4
    s_and_saveexec_b64 s[96:97], vcc
    buffer_store_dwordx4 v[164:167], v8, s[76:79], s90 offen sc1
    s_mov_b64 exec, s[96:97]
    s_branch L_fin
L_X:
    s_sub_u32 s90, s82, 16
    s_lshr_b32 s87, s90, 3
    s_and_b32 s91, s90, 7
    s_lshr_b32 s85, s81, 2
    s_and_b32 s86, s81, 3
    s_lshl_b32 s86, s86, 3
    s_add_u32 s86, s86, s91
    s_mul_i32 s83, s81, 9
    s_add_u32 s83, s83, s90
    s_mov_b32 s84, s90
    s_waitcnt lgkmcnt(0)
    s_add_u32 s88, s0, 1
    s_and_b32 s88, s88, 0xbfffbfff
    s_and_b32 s89, s1, 0xbfffbfff
    s_cmp_ge_u32 s80, 4
    s_cbranch_scc1 L_XB
    s_cmp_eq_u32 s80, 0
    s_cbranch_scc0 L_X_noS1
    s_mov_b32 s26, s86
    s_mov_b32 s27, s87
    s_lshr_b32 s90, s84, 2
    s_lshl_b32 s86, s81, 2
    s_add_u32 s86, s86, s90
    s_and_b32 s87, s84, 3
    s_add_u32 s87, s87, 4
    s_branch L_S1
L_X0_afterS1:
    s_mov_b32 s86, s26
    s_mov_b32 s87, s27
L_X_noS1:
    s_barrier
    s_lshl_b32 s90, s85, 5
    s_lshl_b32 s91, s87, 4
    s_add_u32 s90, s90, s91
    s_lshl_b32 s90, s90, 11
    s_add_u32 s90, s90, 262144
    s_lshl_b32 s91, s80, 13
    s_add_u32 s95, s90, s91
    v_lshlrev_b32 v6, 4, v2
    s_mul_i32 s91, s80, 4224
    s_add_u32 s91, s91, 135168
    v_lshlrev_b32 v7, 3, v2
    v_add_u32 v7, s91, v7
    s_barrier
L_G2_poll:
    s_add_u32 s92, s95, 0
    buffer_load_dwordx4 v[48:51], v6, s[76:79], s92 offen sc1
    s_add_u32 s92, s95, 1024
    buffer_load_dwordx4 v[52:55], v6, s[76:79], s92 offen sc1
    s_add_u32 s92, s95, 2048
    buffer_load_dwordx4 v[56:59], v6, s[76:79], s92 offen sc1
    s_add_u32 s92, s95, 3072
    buffer_load_dwordx4 v[60:63], v6, s[76:79], s92 offen sc1
    s_add_u32 s92, s95, 4096
    buffer_load_dwordx4 v[64:67], v6, s[76:79], s92 offen sc1
    s_add_u32 s92, s95, 5120
    buffer_load_dwordx4 v[68:71], v6, s[76:79], s92 offen sc1
    s_add_u32 s92, s95, 6144
    buffer_load_dwordx4 v[72:75], v6, s[76:79], s92 offen sc1
    s_add_u32 s92, s95, 7168
    buffer_load_dwordx4 v[76:79], v6, s[76:79], s92 offen sc1
    s_waitcnt vmcnt(0)
    s_mov_b64 s[98:99], 0
    v_cmp_ne_u64 vcc, s[88:89], v[50:51]
    s_or_b64 s[98:99], s[98:99], vcc
    v_cmp_ne_u64 vcc, s[88:89], v[54:55]
    s_or_b64 s[98:99], s[98:99], vcc
    v_cmp_ne_u64 vcc, s[88:89], v[58:59]
    s_or_b64 s[98:99], s[98:99], vcc
    v_cmp_ne_u64 vcc, s[88:89], v[62:63]
    s_or_b64 s[98:99], s[98:99], vcc
    v_cmp_ne_u64 vcc, s[88:89], v[66:67]
    s_or_b64 s[98:99], s[98:99], vcc
    v_cmp_ne_u64 vcc, s[88:89], v[70:71]
    s_or_b64 s[98:99], s[98:99], vcc
    v_cmp_ne_u64 vcc, s[88:89], v[74:75]
    s_or_b64 s[98:99], s[98:99], vcc
    v_cmp_ne_u64 vcc, s[88:89], v[78:79]
    s_or_b64 s[98:99], s[98:99], vcc
    s_add_u32 s94, s94, 1
    s_cmp_gt_u32 s94, 400000
    s_cbranch_scc1 L_fin
    s_cmp_lg_u64 s[98:99], 0
    s_cbranch_scc1 L_G2_poll
    ds_write_b64 v7, v[48:49] offset:0
    ds_write_b64 v7, v[52:53] offset:512
    ds_write_b64 v7, v[56:57] offset:1056
    ds_write_b64 v7, v[60:61] offset:1568
    ds_write_b64 v7, v[64:65] offset:2112
    ds_write_b64 v7, v[68:69] offset:2624
    ds_write_b64 v7, v[72:73] offset:3168
    ds_write_b64 v7, v[76:77] offset:3680
    v_mul_u32_u24 v5, 1056, v3
    v_lshl_add_u32 v5, v4, 4, v5
    v_add_u32 v5, 135168, v5
    s_lshl_b32 s90, s80, 5
    v_add_u32 v10, s90, v3
    v_mul_u32_u24 v6, 1056, v10
    v_lshl_add_u32 v6, v4, 4, v6
    s_waitcnt lgkmcnt(0)
    s_barrier
    v_mov_b32 v76, 0
    v_mov_b32 v77, 0
    v_mov_b32 v78, 0
    v_mov_b32 v79, 0
    v_mov_b32 v80, 0
    v_mov_b32 v81, 0
    v_mov_b32 v82, 0
    v_mov_b32 v83, 0
    ds_read_b128 v[16:19], v5 offset:0
    ds_read_b128 v[36:39], v6 offset:0
    ds_read_b128 v[40:43], v6 offset:16896
    ds_read_b128 v[20:23], v5 offset:64
    ds_read_b128 v[44:47], v6 offset:64
    ds_read_b128 v[48:51], v6 offset:16960
    ds_read_b128 v[24:27], v5 offset:128
    ds_read_b128 v[52:55], v6 offset:128
    ds_read_b128 v[56:59], v6 offset:17024
    ds_read_b128 v[28:31], v5 offset:192
    ds_read_b128 v[60:63], v6 offset:192
    ds_read_b128 v[64:67], v6 offset:17088
    ds_read_b128 v[32:35], v5 offset:256
    ds_read_b128 v[68:71], v6 offset:256
    ds_read_b128 v[72:75], v6 offset:17152
    s_waitcnt lgkmcnt(12)
    v_mfma_f32_16x16x32_bf16 v[76:79], v[36:39], v[16:19], v[76:79]
    v_mfma_f32_16x16x32_bf16 v[80:83], v[40:43], v[16:19], v[80:83]
    ds_read_b128 v[16:19], v5 offset:320
    ds_read_b128 v[36:39], v6 offset:320
    ds_read_b128 v[40:43], v6 offset:17216
    s_waitcnt lgkmcnt(12)
    v_mfma_f32_16x16x32_bf16 v[76:79], v[44:47], v[20:23], v[76:79]
    v_mfma_f32_16x16x32_bf16 v[80:83], v[48:51], v[20:23], v[80:83]
    ds_read_b128 v[20:23], v5 offset:384
    ds_read_b128 v[44:47], v6 offset:384
    ds_read_b128 v[48:51], v6 offset:17280
    s_waitcnt lgkmcnt(12)
    v_mfma_f32_16x16x32_bf16 v[76:79], v[52:55], v[24:27], v[76:79]
    v_mfma_f32_16x16x32_bf16 v[80:83], v[56:59], v[24:27], v[80:83]
    ds_read_b128 v[24:27], v5 offset:448
    ds_read_b128 v[52:55], v6 offset:448
    ds_read_b128 v[56:59], v6 offset:17344
    s_waitcnt lgkmcnt(12)
    v_mfma_f32_16x16x32_bf16 v[76:79], v[60:63], v[28:31], v[76:79]
    v_mfma_f32_16x16x32_bf16 v[80:83], v[64:67], v[28:31], v[80:83]
    ds_read_b128 v[28:31], v5 offset:512
    ds_read_b128 v[60:63], v6 offset:512
    ds_read_b128 v[64:67], v6 offset:17408
    s_waitcnt lgkmcnt(12)
    v_mfma_f32_16x16x32_bf16 v[76:79], v[68:71], v[32:35], v[76:79]
    v_mfma_f32_16x16x32_bf16 v[80:83], v[72:75], v[32:35], v[80:83]
    ds_read_b128 v[32:35], v5 offset:576
    ds_read_b128 v[68:71], v6 offset:576
    ds_read_b128 v[72:75], v6 offset:17472
    s_waitcnt lgkmcnt(12)
    v_mfma_f32_16x16x32_bf16 v[76:79], v[36:39], v[16:19], v[76:79]
    v_mfma_f32_16x16x32_bf16 v[80:83], v[40:43], v[16:19], v[80:83]
    ds_read_b128 v[16:19], v5 offset:640
    ds_read_b128 v[36:39], v6 offset:640
    ds_read_b128 v[40:43], v6 offset:17536
    s_waitcnt lgkmcnt(12)
    v_mfma_f32_16x16x32_bf16 v[76:79], v[44:47], v[20:23], v[76:79]
    v_mfma_f32_16x16x32_bf16 v[80:83], v[48:51], v[20:23], v[80:83]
    ds_read_b128 v[20:23], v5 offset:704
    ds_read_b128 v[44:47], v6 offset:704
    ds_read_b128 v[48:51], v6 offset:17600
    s_waitcnt lgkmcnt(12)
    v_mfma_f32_16x16x32_bf16 v[76:79], v[52:55], v[24:27], v[76:79]
    v_mfma_f32_16x16x32_bf16 v[80:83], v[56:59], v[24:27], v[80:83]
    ds_read_b128 v[24:27], v5 offset:768
    ds_read_b128 v[52:55], v6 offset:768
    ds_read_b128 v[56:59], v6 offset:17664
    s_waitcnt lgkmcnt(12)
    v_mfma_f32_16x16x32_bf16 v[76:79], v[60:63], v[28:31], v[76:79]
    v_mfma_f32_16x16x32_bf16 v[80:83], v[64:67], v[28:31], v[80:83]
    ds_read_b128 v[28:31], v5 offset:832
    ds_read_b128 v[60:63], v6 offset:832
    ds_read_b128 v[64:67], v6 offset:17728
    s_waitcnt lgkmcnt(12)
    v_mfma_f32_16x16x32_bf16 v[76:79], v[68:71], v[32:35], v[76:79]
    v_mfma_f32_16x16x32_bf16 v[80:83], v[72:75], v[32:35], v[80:83]
    ds_read_b128 v[32:35], v5 offset:896
    ds_read_b128 v[68:71], v6 offset:896
    ds_read_b128 v[72:75], v6 offset:17792
    s_waitcnt lgkmcnt(12)
    v_mfma_f32_16x16x32_bf16 v[76:79], v[36:39], v[16:19], v[76:79]
    v_mfma_f32_16x16x32_bf16 v[80:83], v[40:43], v[16:19], v[80:83]
    ds_read_b128 v[16:19], v5 offset:960
    ds_read_b128 v[36:39], v6 offset:960
    ds_read_b128 v[40:43], v6 offset:17856
    s_waitcnt lgkmcnt(12)
    v_mfma_f32_16x16x32_bf16 v[76:79], v[44:47], v[20:23], v[76:79]
    v_mfma_f32_16x16x32_bf16 v[80:83], v[48:51], v[20:23], v[80:83]
    s_waitcnt lgkmcnt(9)
    v_mfma_f32_16x16x32_bf16 v[76:79], v[52:55], v[24:27], v[76:79]
    v_mfma_f32_16x16x32_bf16 v[80:83], v[56:59], v[24:27], v[80:83]
    s_waitcnt lgkmcnt(6)
    v_mfma_f32_16x16x32_bf16 v[76:79], v[60:63], v[28:31], v[76:79]
    v_mfma_f32_16x16x32_bf16 v[80:83], v[64:67], v[28:31], v[80:83]
    s_waitcnt lgkmcnt(3)
    v_mfma_f32_16x16x32_bf16 v[76:79], v[68:71], v[32:35], v[76:79]
    v_mfma_f32_16x16x32_bf16 v[80:83], v[72:75], v[32:35], v[80:83]
    s_waitcnt lgkmcnt(0)
    v_mfma_f32_16x16x32_bf16 v[76:79], v[36:39], v[16:19], v[76:79]
    v_mfma_f32_16x16x32_bf16 v[80:83], v[40:43], v[16:19], v[80:83]
    s_mov_b32 s90, 0x3e0293ee
    s_nop 5
    v_mul_f32 v76, s90, v76
    v_mul_f32 v77, s90, v77
    v_mul_f32 v78, s90, v78
    v_mul_f32 v79, s90, v79
    v_mul_f32 v80, s90, v80
    v_mul_f32 v81, s90, v81
    v_mul_f32 v82, s90, v82
    v_mul_f32 v83, s90, v83
    v_max3_f32 v116, v76, v77, v78
    v_max3_f32 v116, v116, v79, v80
    v_max3_f32 v116, v116, v81, v82
    v_max_f32 v116, v116, v83
    v_mov_b32 v10, v116
    s_nop 1
    v_permlane16_swap_b32 v116, v10
    v_max_f32 v116, v116, v10
    v_mov_b32 v10, v116
    s_nop 1
    v_permlane32_swap_b32 v116, v10
    v_max_f32 v116, v116, v10
    s_lshl_b32 s91, s80, 6
    v_lshlrev_b32 v7, 2, v3
    v_add_u32 v7, 156672, v7
    v_add_u32 v8, s91, v7
    ds_write_b32 v8, v116
    s_waitcnt lgkmcnt(0)
    s_barrier
    ds_read_b32 v10, v7 offset:0
    ds_read_b32 v11, v7 offset:64
    ds_read_b32 v12, v7 offset:128
    ds_read_b32 v13, v7 offset:192
    s_waitcnt lgkmcnt(0)
    v_max3_f32 v116, v10, v11, v12
    v_max_f32 v116, v116, v13
    v_sub_f32 v76, v76, v116
    v_sub_f32 v77, v77, v116
    v_sub_f32 v78, v78, v116
    v_sub_f32 v79, v79, v116
    v_sub_f32 v80, v80, v116
    v_sub_f32 v81, v81, v116
    v_sub_f32 v82, v82, v116
    v_sub_f32 v83, v83, v116
    v_exp_f32 v76, v76
    v_exp_f32 v77, v77
    v_exp_f32 v78, v78
    v_exp_f32 v79, v79
    v_exp_f32 v80, v80
    v_exp_f32 v81, v81
    v_exp_f32 v82, v82
    v_exp_f32 v83, v83
    v_add_f32 v117, v76, v77
    v_add_f32 v117, v117, v78
    v_add_f32 v117, v117, v79
    v_add_f32 v117, v117, v80
    v_add_f32 v117, v117, v81
    v_add_f32 v117, v117, v82
    v_add_f32 v117, v117, v83
    v_mov_b32 v10, v117
    s_nop 1
    v_permlane16_swap_b32 v117, v10
    v_add_f32 v117, v117, v10
    v_mov_b32 v10, v117
    s_nop 1
    v_permlane32_swap_b32 v117, v10
    v_add_f32 v117, v117, v10
    ds_write_b32 v8, v117 offset:256
    v_mul_u32_u24 v9, 288, v3
    v_add_u32 v9, 152064, v9
    s_lshl_b32 s91, s80, 6
    v_lshl_add_u32 v10, v4, 4, v9
    v_add_u32 v10, s91, v10
    v_cvt_pk_bf16_f32 v12, v76, v77
    v_cvt_pk_bf16_f32 v13, v78, v79
    v_cvt_pk_bf16_f32 v14, v80, v81
    v_cvt_pk_bf16_f32 v15, v82, v83
    ds_write_b128 v10, v[12:15]
    s_waitcnt lgkmcnt(0)
    s_barrier
    v_lshl_add_u32 v9, v4, 4, v9
    ds_read_b128 v[16:19], v9 offset:0
    ds_read_b128 v[20:23], v9 offset:64
    ds_read_b128 v[24:27], v9 offset:128
    ds_read_b128 v[28:31], v9 offset:192
    ds_read_b32 v10, v7 offset:256
    ds_read_b32 v11, v7 offset:320
    ds_read_b32 v12, v7 offset:384
    ds_read_b32 v13, v7 offset:448
    v_lshrrev_b32 v14, 2, v3
    v_lshl_add_u32 v14, v4, 2, v14
    v_mul_u32_u24 v5, 1056, v14
    v_and_b32 v14, 3, v3
    v_lshl_add_u32 v5, v14, 3, v5
    s_lshl_b32 s91, s80, 8
    v_add_u32 v5, s91, v5
    v_add_u32 v6, 67584, v5
    v_mov_b32 v84, 0
    v_mov_b32 v85, 0
    v_mov_b32 v86, 0
    v_mov_b32 v87, 0
    v_mov_b32 v88, 0
    v_mov_b32 v89, 0
    v_mov_b32 v90, 0
    v_mov_b32 v91, 0
    v_mov_b32 v92, 0
    v_mov_b32 v93, 0
    v_mov_b32 v94, 0
    v_mov_b32 v95, 0
    v_mov_b32 v96, 0
    v_mov_b32 v97, 0
    v_mov_b32 v98, 0
    v_mov_b32 v99, 0
    v_mov_b32 v100, 0
    v_mov_b32 v101, 0
    v_mov_b32 v102, 0
    v_mov_b32 v103, 0
    v_mov_b32 v104, 0
    v_mov_b32 v105, 0
    v_mov_b32 v106, 0
    v_mov_b32 v107, 0
    v_mov_b32 v108, 0
    v_mov_b32 v109, 0
    v_mov_b32 v110, 0
    v_mov_b32 v111, 0
    v_mov_b32 v112, 0
    v_mov_b32 v113, 0
    v_mov_b32 v114, 0
    v_mov_b32 v115, 0
    s_waitcnt lgkmcnt(0)
    v_add_f32 v117, v10, v11
    v_add_f32 v12, v12, v13
    v_add_f32 v117, v117, v12
    ds_read_b64_tr_b16 v[32:33], v5 offset:0
    ds_read_b64_tr_b16 v[34:35], v5 offset:16896
    ds_read_b64_tr_b16 v[36:37], v5 offset:32
    ds_read_b64_tr_b16 v[38:39], v5 offset:16928
    ds_read_b64_tr_b16 v[40:41], v5 offset:64
    ds_read_b64_tr_b16 v[42:43], v5 offset:16960
    ds_read_b64_tr_b16 v[44:45], v5 offset:96
    ds_read_b64_tr_b16 v[46:47], v5 offset:16992
    ds_read_b64_tr_b16 v[48:49], v5 offset:128
    ds_read_b64_tr_b16 v[50:51], v5 offset:17024
    ds_read_b64_tr_b16 v[52:53], v5 offset:160
    ds_read_b64_tr_b16 v[54:55], v5 offset:17056
    ds_read_b64_tr_b16 v[56:57], v5 offset:192
    ds_read_b64_tr_b16 v[58:59], v5 offset:17088
    s_waitcnt lgkmcnt(12)
    v_mfma_f32_16x16x32_bf16 v[84:87], v[16:19], v[32:35], v[84:87]
    ds_read_b64_tr_b16 v[60:61], v5 offset:224
    ds_read_b64_tr_b16 v[62:63], v5 offset:17120
    s_waitcnt lgkmcnt(12)
    v_mfma_f32_16x16x32_bf16 v[88:91], v[16:19], v[36:39], v[88:91]
    ds_read_b64_tr_b16 v[32:33], v5 offset:33792
    ds_read_b64_tr_b16 v[34:35], v5 offset:50688
    s_waitcnt lgkmcnt(12)
    v_mfma_f32_16x16x32_bf16 v[92:95], v[16:19], v[40:43], v[92:95]
    ds_read_b64_tr_b16 v[36:37], v5 offset:33824
    ds_read_b64_tr_b16 v[38:39], v5 offset:50720
    s_waitcnt lgkmcnt(12)
    v_mfma_f32_16x16x32_bf16 v[96:99], v[16:19], v[44:47], v[96:99]
    ds_read_b64_tr_b16 v[40:41], v5 offset:33856
    ds_read_b64_tr_b16 v[42:43], v5 offset:50752
    s_waitcnt lgkmcnt(12)
    v_mfma_f32_16x16x32_bf16 v[100:103], v[16:19], v[48:51], v[100:103]
    ds_read_b64_tr_b16 v[44:45], v5 offset:33888
    ds_read_b64_tr_b16 v[46:47], v5 offset:50784
    s_waitcnt lgkmcnt(12)
    v_mfma_f32_16x16x32_bf16 v[104:107], v[16:19], v[52:55], v[104:107]
    ds_read_b64_tr_b16 v[48:49], v5 offset:33920
    ds_read_b64_tr_b16 v[50:51], v5 offset:50816
    s_waitcnt lgkmcnt(12)
    v_mfma_f32_16x16x32_bf16 v[108:111], v[16:19], v[56:59], v[108:111]
    ds_read_b64_tr_b16 v[52:53], v5 offset:33952
    ds_read_b64_tr_b16 v[54:55], v5 offset:50848
    s_waitcnt lgkmcnt(12)
    v_mfma_f32_16x16x32_bf16 v[112:115], v[16:19], v[60:63], v[112:115]
    ds_read_b64_tr_b16 v[56:57], v5 offset:33984
    ds_read_b64_tr_b16 v[58:59], v5 offset:50880
    s_waitcnt lgkmcnt(12)
    v_mfma_f32_16x16x32_bf16 v[84:87], v[20:23], v[32:35], v[84:87]
    ds_read_b64_tr_b16 v[60:61], v5 offset:34016
    ds_read_b64_tr_b16 v[62:63], v5 offset:50912
    s_waitcnt lgkmcnt(12)
    v_mfma_f32_16x16x32_bf16 v[88:91], v[20:23], v[36:39], v[88:91]
    ds_read_b64_tr_b16 v[32:33], v6 offset:0
    ds_read_b64_tr_b16 v[34:35], v6 offset:16896
    s_waitcnt lgkmcnt(12)
    v_mfma_f32_16x16x32_bf16 v[92:95], v[20:23], v[40:43], v[92:95]
    ds_read_b64_tr_b16 v[36:37], v6 offset:32
    ds_read_b64_tr_b16 v[38:39], v6 offset:16928
    s_waitcnt lgkmcnt(12)
    v_mfma_f32_16x16x32_bf16 v[96:99], v[20:23], v[44:47], v[96:99]
    ds_read_b64_tr_b16 v[40:41], v6 offset:64
    ds_read_b64_tr_b16 v[42:43], v6 offset:16960
    s_waitcnt lgkmcnt(12)
    v_mfma_f32_16x16x32_bf16 v[100:103], v[20:23], v[48:51], v[100:103]
    ds_read_b64_tr_b16 v[44:45], v6 offset:96
    ds_read_b64_tr_b16 v[46:47], v6 offset:16992
    s_waitcnt lgkmcnt(12)
    v_mfma_f32_16x16x32_bf16 v[104:107], v[20:23], v[52:55], v[104:107]
    ds_read_b64_tr_b16 v[48:49], v6 offset:128
    ds_read_b64_tr_b16 v[50:51], v6 offset:17024
    s_waitcnt lgkmcnt(12)
    v_mfma_f32_16x16x32_bf16 v[108:111], v[20:23], v[56:59], v[108:111]
    ds_read_b64_tr_b16 v[52:53], v6 offset:160
    ds_read_b64_tr_b16 v[54:55], v6 offset:17056
    s_waitcnt lgkmcnt(12)
    v_mfma_f32_16x16x32_bf16 v[112:115], v[20:23], v[60:63], v[112:115]
    ds_read_b64_tr_b16 v[56:57], v6 offset:192
    ds_read_b64_tr_b16 v[58:59], v6 offset:17088
    s_waitcnt lgkmcnt(12)
    v_mfma_f32_16x16x32_bf16 v[84:87], v[24:27], v[32:35], v[84:87]
    ds_read_b64_tr_b16 v[60:61], v6 offset:224
    ds_read_b64_tr_b16 v[62:63], v6 offset:17120
    s_waitcnt lgkmcnt(12)
    v_mfma_f32_16x16x32_bf16 v[88:91], v[24:27], v[36:39], v[88:91]
    ds_read_b64_tr_b16 v[32:33], v6 offset:33792
    ds_read_b64_tr_b16 v[34:35], v6 offset:50688
    s_waitcnt lgkmcnt(12)
    v_mfma_f32_16x16x32_bf16 v[92:95], v[24:27], v[40:43], v[92:95]
    ds_read_b64_tr_b16 v[36:37], v6 offset:33824
    ds_read_b64_tr_b16 v[38:39], v6 offset:50720
    s_waitcnt lgkmcnt(12)
    v_mfma_f32_16x16x32_bf16 v[96:99], v[24:27], v[44:47], v[96:99]
    ds_read_b64_tr_b16 v[40:41], v6 offset:33856
    ds_read_b64_tr_b16 v[42:43], v6 offset:50752
    s_waitcnt lgkmcnt(12)
    v_mfma_f32_16x16x32_bf16 v[100:103], v[24:27], v[48:51], v[100:103]
    ds_read_b64_tr_b16 v[44:45], v6 offset:33888
    ds_read_b64_tr_b16 v[46:47], v6 offset:50784
    s_waitcnt lgkmcnt(12)
    v_mfma_f32_16x16x32_bf16 v[104:107], v[24:27], v[52:55], v[104:107]
    ds_read_b64_tr_b16 v[48:49], v6 offset:33920
    ds_read_b64_tr_b16 v[50:51], v6 offset:50816
    s_waitcnt lgkmcnt(12)
    v_mfma_f32_16x16x32_bf16 v[108:111], v[24:27], v[56:59], v[108:111]
    ds_read_b64_tr_b16 v[52:53], v6 offset:33952
    ds_read_b64_tr_b16 v[54:55], v6 offset:50848
    s_waitcnt lgkmcnt(12)
    v_mfma_f32_16x16x32_bf16 v[112:115], v[24:27], v[60:63], v[112:115]
    ds_read_b64_tr_b16 v[56:57], v6 offset:33984
    ds_read_b64_tr_b16 v[58:59], v6 offset:50880
    s_waitcnt lgkmcnt(12)
    v_mfma_f32_16x16x32_bf16 v[84:87], v[28:31], v[32:35], v[84:87]
    ds_read_b64_tr_b16 v[60:61], v6 offset:34016
    ds_read_b64_tr_b16 v[62:63], v6 offset:50912
    s_waitcnt lgkmcnt(12)
    v_mfma_f32_16x16x32_bf16 v[88:91], v[28:31], v[36:39], v[88:91]
    s_waitcnt lgkmcnt(10)
    v_mfma_f32_16x16x32_bf16 v[92:95], v[28:31], v[40:43], v[92:95]
    s_waitcnt lgkmcnt(8)
    v_mfma_f32_16x16x32_bf16 v[96:99], v[28:31], v[44:47], v[96:99]
    s_waitcnt lgkmcnt(6)
    v_mfma_f32_16x16x32_bf16 v[100:103], v[28:31], v[48:51], v[100:103]
    s_waitcnt lgkmcnt(4)
    v_mfma_f32_16x16x32_bf16 v[104:107], v[28:31], v[52:55], v[104:107]
    s_waitcnt lgkmcnt(2)
    v_mfma_f32_16x16x32_bf16 v[108:111], v[28:31], v[56:59], v[108:111]
    s_waitcnt lgkmcnt(0)
    v_mfma_f32_16x16x32_bf16 v[112:115], v[28:31], v[60:63], v[112:115]
    s_lshl_b32 s90, s87, 20
    s_lshl_b32 s91, s80, 14
    s_add_u32 s90, s90, s91
    s_lshl_b32 s91, s85, 12
    s_add_u32 s90, s90, s91
    s_lshl_b32 s91, s86, 7
    s_add_u32 s90, s90, s91
    s_add_u32 s90, s90, 1048576
    v_lshlrev_b32 v5, 18, v4
    v_lshl_add_u32 v5, v3, 3, v5
    v_cvt_pk_bf16_f32 v16, v84, v88
    v_cvt_pk_bf16_f32 v17, v92, v96
    s_add_u32 s91, s90, 0
    buffer_store_dwordx2 v[16:17], v5, s[76:79], s91 offen sc1
    v_cvt_pk_bf16_f32 v18, v100, v104
    v_cvt_pk_bf16_f32 v19, v108, v112
    s_add_u32 s91, s90, 8192
    buffer_store_dwordx2 v[18:19], v5, s[76:79], s91 offen sc1
    v_cvt_pk_bf16_f32 v20, v85, v89
    v_cvt_pk_bf16_f32 v21, v93, v97
    s_add_u32 s91, s90, 65536
    buffer_store_dwordx2 v[20:21], v5, s[76:79], s91 offen sc1
    v_cvt_pk_bf16_f32 v22, v101, v105
    v_cvt_pk_bf16_f32 v23, v109, v113
    s_add_u32 s91, s90, 73728
    buffer_store_dwordx2 v[22:23], v5, s[76:79], s91 offen sc1
    v_cvt_pk_bf16_f32 v24, v86, v90
    v_cvt_pk_bf16_f32 v25, v94, v98
    s_add_u32 s91, s90, 131072
    buffer_store_dwordx2 v[24:25], v5, s[76:79], s91 offen sc1
    v_cvt_pk_bf16_f32 v26, v102, v106
    v_cvt_pk_bf16_f32 v27, v110, v114
    s_add_u32 s91, s90, 139264
    buffer_store_dwordx2 v[26:27], v5, s[76:79], s91 offen sc1
    v_cvt_pk_bf16_f32 v28, v87, v91
    v_cvt_pk_bf16_f32 v29, v95, v99
    s_add_u32 s91, s90, 196608
    buffer_store_dwordx2 v[28:29], v5, s[76:79], s91 offen sc1
    v_cvt_pk_bf16_f32 v30, v103, v107
    v_cvt_pk_bf16_f32 v31, v111, v115
    s_add_u32 s91, s90, 204800
    buffer_store_dwordx2 v[30:31], v5, s[76:79], s91 offen sc1
    s_lshl_b32 s90, s87, 17
    s_lshl_b32 s91, s80, 11
    s_add_u32 s90, s90, s91
    s_lshl_b32 s91, s85, 9
    s_add_u32 s90, s90, s91
    s_lshl_b32 s91, s86, 4
    s_add_u32 s90, s90, s91
    s_add_u32 s90, s90, 524288
    v_lshlrev_b32 v5, 13, v3
    v_lshl_add_u32 v5, v4, 10, v5
    v_mov_b32 v32, v116
    v_mov_b32 v33, v117
    v_mov_b32 v34, s88
    v_mov_b32 v35, s89
    v_cmp_gt_u32 vcc, 2, v4
    s_and_saveexec_b64 s[96:97], vcc
    s_waitcnt vmcnt(0)
    buffer_store_dwordx4 v[32:35], v5, s[76:79], s90 offen sc1
    s_mov_b64 exec, s[96:97]
    s_barrier
    s_cmp_ge_u32 s84, 9
    s_cbranch_scc1 L_fin
    s_cmp_eq_u32 s80, 0
    s_cbranch_scc1 L_X0_tile8
    s_cmp_eq_u32 s80, 3
    s_cbranch_scc1 L_X3
    s_sub_u32 s84, s80, 1
    v_lshlrev_b32 v6, 1, v2
    s_mul_i32 s91, s84, 1536
    s_add_u32 s91, s91, 157184
    v_add_u32 v7, 0, v6
    s_movk_i32 s93, 1821
    v_mul_u32_u24 v8, s93, v7
    v_lshrrev_b32 v8, 16, v8
    v_mul_u32_u24 v9, 36, v8
    v_sub_u32 v9, v7, v9
    s_movk_i32 s93, 7282
    v_mul_u32_u24 v10, s93, v9
    v_lshrrev_b32 v10, 16, v10
    v_mul_u32_u24 v11, 9, v10
    v_sub_u32 v11, v9, v11
    v_mul_u32_u24 v8, 192, v8
    v_mul_u32_u24 v10, 48, v10
    v_add3_u32 v8, v8, v10, s91
    v_lshl_add_u32 v120, v11, 2, v8
    v_add_u32 v7, 1, v6
    s_movk_i32 s93, 1821
    v_mul_u32_u24 v8, s93, v7
    v_lshrrev_b32 v8, 16, v8
    v_mul_u32_u24 v9, 36, v8
    v_sub_u32 v9, v7, v9
    s_movk_i32 s93, 7282
    v_mul_u32_u24 v10, s93, v9
    v_lshrrev_b32 v10, 16, v10
    v_mul_u32_u24 v11, 9, v10
    v_sub_u32 v11, v9, v11
    v_mul_u32_u24 v8, 192, v8
    v_mul_u32_u24 v10, 48, v10
    v_add3_u32 v8, v8, v10, s91
    v_lshl_add_u32 v121, v11, 2, v8
    v_add_u32 v7, 128, v6
    s_movk_i32 s93, 1821
    v_mul_u32_u24 v8, s93, v7
    v_lshrrev_b32 v8, 16, v8
    v_mul_u32_u24 v9, 36, v8
    v_sub_u32 v9, v7, v9
    s_movk_i32 s93, 7282
    v_mul_u32_u24 v10, s93, v9
    v_lshrrev_b32 v10, 16, v10
    v_mul_u32_u24 v11, 9, v10
    v_sub_u32 v11, v9, v11
    v_mul_u32_u24 v8, 192, v8
    v_mul_u32_u24 v10, 48, v10
    v_add3_u32 v8, v8, v10, s91
    v_lshl_add_u32 v122, v11, 2, v8
    v_add_u32 v7, 129, v6
    s_movk_i32 s93, 1821
    v_mul_u32_u24 v8, s93, v7
    v_lshrrev_b32 v8, 16, v8
    v_mul_u32_u24 v9, 36, v8
    v_sub_u32 v9, v7, v9
    s_movk_i32 s93, 7282
    v_mul_u32_u24 v10, s93, v9
    v_lshrrev_b32 v10, 16, v10
    v_mul_u32_u24 v11, 9, v10
    v_sub_u32 v11, v9, v11
    v_mul_u32_u24 v8, 192, v8
    v_mul_u32_u24 v10, 48, v10
    v_add3_u32 v8, v8, v10, s91
    v_lshl_add_u32 v123, v11, 2, v8
    v_add_u32 v7, 256, v6
    s_movk_i32 s93, 1821
    v_mul_u32_u24 v8, s93, v7
    v_lshrrev_b32 v8, 16, v8
    v_mul_u32_u24 v9, 36, v8
    v_sub_u32 v9, v7, v9
    s_movk_i32 s93, 7282
    v_mul_u32_u24 v10, s93, v9
    v_lshrrev_b32 v10, 16, v10
    v_mul_u32_u24 v11, 9, v10
    v_sub_u32 v11, v9, v11
    v_mul_u32_u24 v8, 192, v8
    v_mul_u32_u24 v10, 48, v10
    v_add3_u32 v8, v8, v10, s91
    v_lshl_add_u32 v124, v11, 2, v8
    v_add_u32 v7, 257, v6
    s_movk_i32 s93, 1821
    v_mul_u32_u24 v8, s93, v7
    v_lshrrev_b32 v8, 16, v8
    v_mul_u32_u24 v9, 36, v8
    v_sub_u32 v9, v7, v9
    s_movk_i32 s93, 7282
    v_mul_u32_u24 v10, s93, v9
    v_lshrrev_b32 v10, 16, v10
    v_mul_u32_u24 v11, 9, v10
    v_sub_u32 v11, v9, v11
    v_mul_u32_u24 v8, 192, v8
    v_mul_u32_u24 v10, 48, v10
    v_add3_u32 v8, v8, v10, s91
    v_lshl_add_u32 v125, v11, 2, v8
    v_lshlrev_b32 v5, 4, v2
    s_mul_i32 s90, s81, 4608
    s_mul_i32 s91, s84, 2304
    s_add_u32 s90, s90, s91
    s_add_u32 s95, s90, 6291456
    s_add_u32 s92, s30, s95
    s_addc_u32 s93, s31, 0
L_G5_sent:
    s_load_dwordx2 s[36:37], s[92:93], 568 glc
    s_load_dwordx2 s[38:39], s[92:93], 1144 glc
    s_load_dwordx2 s[40:41], s[92:93], 1720 glc
    s_load_dwordx2 s[42:43], s[92:93], 2296 glc
    s_waitcnt lgkmcnt(0)
    s_mov_b64 s[98:99], 0
    s_xor_b64 s[36:37], s[36:37], s[88:89]
    s_or_b64 s[98:99], s[98:99], s[36:37]
    s_xor_b64 s[38:39], s[38:39], s[88:89]
    s_or_b64 s[98:99], s[98:99], s[38:39]
    s_xor_b64 s[40:41], s[40:41], s[88:89]
    s_or_b64 s[98:99], s[98:99], s[40:41]
    s_xor_b64 s[42:43], s[42:43], s[88:89]
    s_or_b64 s[98:99], s[98:99], s[42:43]
    s_add_u32 s94, s94, 1
    s_cmp_gt_u32 s94, 400000
    s_cbranch_scc1 L_fin
    s_cmp_eq_u64 s[98:99], 0
    s_cbranch_scc1 L_G5_sent_ok
    s_sleep 4
    s_branch L_G5_sent
L_G5_sent_ok:
    v_mov_b32 v56, 0
    v_mov_b32 v57, 0
    v_mov_b32 v58, s88
    v_mov_b32 v59, s89
L_G5_poll:
    buffer_load_dwordx4 v[48:51], v5, s[76:79], s95 offen sc1
    buffer_load_dwordx4 v[52:55], v5, s[76:79], s95 offen offset:1024 sc1
    v_cmp_gt_u32 vcc, 16, v2
    s_and_saveexec_b64 s[96:97], vcc
    buffer_load_dwordx4 v[56:59], v5, s[76:79], s95 offen offset:2048 sc1
    s_mov_b64 exec, s[96:97]
    s_waitcnt vmcnt(0)
    s_mov_b64 s[98:99], 0
    v_cmp_ne_u64 vcc, s[88:89], v[50:51]
    s_or_b64 s[98:99], s[98:99], vcc
    v_cmp_ne_u64 vcc, s[88:89], v[54:55]
    s_or_b64 s[98:99], s[98:99], vcc
    v_cmp_ne_u64 vcc, s[88:89], v[58:59]
    s_or_b64 s[98:99], s[98:99], vcc
    s_add_u32 s94, s94, 1
    s_cmp_gt_u32 s94, 400000
    s_cbranch_scc1 L_fin
    s_cmp_lg_u64 s[98:99], 0
    s_cbranch_scc1 L_G5_poll
    v_lshlrev_b32 v32, 16, v48
    v_and_b32 v33, 0xffff0000, v48
    v_lshlrev_b32 v34, 16, v49
    v_and_b32 v35, 0xffff0000, v49
    v_lshlrev_b32 v36, 16, v52
    v_and_b32 v37, 0xffff0000, v52
    v_lshlrev_b32 v38, 16, v53
    v_and_b32 v39, 0xffff0000, v53
    v_lshlrev_b32 v40, 16, v56
    v_and_b32 v41, 0xffff0000, v56
    v_lshlrev_b32 v42, 16, v57
    v_and_b32 v43, 0xffff0000, v57
    v_add_f32 v8, v32, v33
    v_mul_f32 v9, v32, v32
    v_fmac_f32 v9, v33, v33
    v_add_f32 v8, v8, v34
    v_fmac_f32 v9, v34, v34
    v_add_f32 v8, v8, v35
    v_fmac_f32 v9, v35, v35
    v_add_f32 v8, v8, v36
    v_fmac_f32 v9, v36, v36
    v_add_f32 v8, v8, v37
    v_fmac_f32 v9, v37, v37
    v_add_f32 v8, v8, v38
    v_fmac_f32 v9, v38, v38
    v_add_f32 v8, v8, v39
    v_fmac_f32 v9, v39, v39
    v_add_f32 v8, v8, v40
    v_fmac_f32 v9, v40, v40
    v_add_f32 v8, v8, v41
    v_fmac_f32 v9, v41, v41
    v_add_f32 v8, v8, v42
    v_fmac_f32 v9, v42, v42
    v_add_f32 v8, v8, v43
    v_fmac_f32 v9, v43, v43
    s_nop 0
    v_add_f32_dpp v8, v8, v8 row_ror:8 row_mask:0xf bank_mask:0xf
    s_nop 1
    v_add_f32_dpp v8, v8, v8 row_ror:4 row_mask:0xf bank_mask:0xf
    s_nop 1
    v_add_f32_dpp v8, v8, v8 row_ror:2 row_mask:0xf bank_mask:0xf
    s_nop 1
    v_add_f32_dpp v8, v8, v8 row_ror:1 row_mask:0xf bank_mask:0xf
    v_mov_b32 v10, v8
    s_nop 1
    v_permlane16_swap_b32 v8, v10
    v_add_f32 v8, v8, v10
    v_mov_b32 v10, v8
    s_nop 1
    v_permlane32_swap_b32 v8, v10
    v_add_f32 v8, v8, v10
    v_add_f32_dpp v9, v9, v9 row_ror:8 row_mask:0xf bank_mask:0xf
    s_nop 1
    v_add_f32_dpp v9, v9, v9 row_ror:4 row_mask:0xf bank_mask:0xf
    s_nop 1
    v_add_f32_dpp v9, v9, v9 row_ror:2 row_mask:0xf bank_mask:0xf
    s_nop 1
    v_add_f32_dpp v9, v9, v9 row_ror:1 row_mask:0xf bank_mask:0xf
    v_mov_b32 v10, v9
    s_nop 1
    v_permlane16_swap_b32 v9, v10
    v_add_f32 v9, v9, v10
    v_mov_b32 v10, v9
    s_nop 1
    v_permlane32_swap_b32 v9, v10
    v_add_f32 v9, v9, v10
    v_mul_f32 v8, 0x3ae38e39, v8
    v_mul_f32 v9, 0x3ae38e39, v9
    v_fma_f32 v9, -v8, v8, v9
    v_max_f32 v9, 0, v9
    v_add_f32 v9, 0x3727c5ac, v9
    v_rsq_f32 v9, v9
    v_sub_f32 v32, v32, v8
    v_mul_f32 v32, v32, v9
    v_sub_f32 v33, v33, v8
    v_mul_f32 v33, v33, v9
    v_sub_f32 v34, v34, v8
    v_mul_f32 v34, v34, v9
    v_sub_f32 v35, v35, v8
    v_mul_f32 v35, v35, v9
    v_cvt_pk_bf16_f32 v10, v32, v33
    v_cvt_pk_bf16_f32 v11, v34, v35
    ds_write_b32 v120, v10
    ds_write_b32 v121, v11
    v_sub_f32 v36, v36, v8
    v_mul_f32 v36, v36, v9
    v_sub_f32 v37, v37, v8
    v_mul_f32 v37, v37, v9
    v_sub_f32 v38, v38, v8
    v_mul_f32 v38, v38, v9
    v_sub_f32 v39, v39, v8
    v_mul_f32 v39, v39, v9
    v_cvt_pk_bf16_f32 v10, v36, v37
    v_cvt_pk_bf16_f32 v11, v38, v39
    ds_write_b32 v122, v10
    ds_write_b32 v123, v11
    v_cmp_gt_u32 vcc, 16, v2
    s_and_saveexec_b64 s[96:97], vcc
    v_sub_f32 v40, v40, v8
    v_mul_f32 v40, v40, v9
    v_sub_f32 v41, v41, v8
    v_mul_f32 v41, v41, v9
    v_sub_f32 v42, v42, v8
    v_mul_f32 v42, v42, v9
    v_sub_f32 v43, v43, v8
    v_mul_f32 v43, v43, v9
    v_cvt_pk_bf16_f32 v10, v40, v41
    v_cvt_pk_bf16_f32 v11, v42, v43
    ds_write_b32 v124, v10
    ds_write_b32 v125, v11
    s_mov_b64 exec, s[96:97]
    s_waitcnt lgkmcnt(0)
    s_barrier
    s_lshl_b32 s90, s84, 9
    v_lshlrev_b32 v5, 2, v2
    v_add_u32 v5, s90, v5
    v_lshlrev_b32 v6, 1, v2
    s_lshl_b32 s90, s84, 7
    s_add_u32 s90, s90, 160256
    v_add_u32 v6, s90, v6
    s_barrier
    ds_read_b32 v16, v5 offset:0
    ds_read_b32 v24, v5 offset:256
    ds_read_b32 v17, v5 offset:1024
    ds_read_b32 v25, v5 offset:1280
    ds_read_b32 v18, v5 offset:2048
    ds_read_b32 v26, v5 offset:2304
    ds_read_b32 v19, v5 offset:3072
    ds_read_b32 v27, v5 offset:3328
    ds_read_b32 v20, v5 offset:4096
    ds_read_b32 v28, v5 offset:4352
    ds_read_b32 v21, v5 offset:5120
    ds_read_b32 v29, v5 offset:5376
    ds_read_b32 v22, v5 offset:6144
    ds_read_b32 v30, v5 offset:6400
    ds_read_b32 v23, v5 offset:7168
    ds_read_b32 v31, v5 offset:7424
    s_waitcnt lgkmcnt(0)
    v_add_f32 v16, v16, v17
    v_add_f32 v18, v18, v19
    v_add_f32 v20, v20, v21
    v_add_f32 v22, v22, v23
    v_add_f32 v16, v16, v18
    v_add_f32 v20, v20, v22
    v_add_f32 v16, v16, v20
    v_add_f32 v24, v24, v25
    v_add_f32 v26, v26, v27
    v_add_f32 v28, v28, v29
    v_add_f32 v30, v30, v31
    v_add_f32 v24, v24, v26
    v_add_f32 v28, v28, v30
    v_add_f32 v24, v24, v28
    v_mul_f32 v8, 0xbfb8aa3b, v16
    v_exp_f32 v8, v8
    s_nop 0
    v_add_f32 v8, 1.0, v8
    v_rcp_f32 v8, v8
    s_nop 0
    v_mul_f32 v8, v8, v16
    v_mul_f32 v8, v8, v24
    v_cvt_pk_bf16_f32 v8, v8, v8
    ds_write_b16 v6, v8
    s_waitcnt lgkmcnt(0)
    s_barrier
    s_branch L_fin
L_X3:
    s_barrier
    s_barrier
    s_barrier
    s_branch L_fin
L_XB:
    s_sub_u32 s95, s80, 4
    v_lshlrev_b32 v5, 4, v2
    s_lshl_b32 s90, s85, 22
    s_lshl_b32 s91, s86, 17
    s_add_u32 s90, s90, s91
    s_barrier
    s_xor_b32 s93, s87, 0
    s_lshl_b32 s93, s93, 3
    s_add_u32 s93, s93, s95
    s_lshl_b32 s93, s93, 3
    s_mul_i32 s91, s93, 1056
    s_lshl_b32 s93, s93, 10
    s_add_u32 s93, s93, s90
    s_add_u32 m0, s91, 0
    s_add_u32 s92, s93, 0
    buffer_load_dwordx4 v5, s[36:39], s92 offen  lds
    s_add_u32 m0, s91, 1056
    s_add_u32 s92, s93, 1024
    buffer_load_dwordx4 v5, s[36:39], s92 offen  lds
    s_add_u32 m0, s91, 2112
    s_add_u32 s92, s93, 2048
    buffer_load_dwordx4 v5, s[36:39], s92 offen  lds
    s_add_u32 m0, s91, 3168
    s_add_u32 s92, s93, 3072
    buffer_load_dwordx4 v5, s[36:39], s92 offen  lds
    s_add_u32 m0, s91, 4224
    s_add_u32 s92, s93, 4096
    buffer_load_dwordx4 v5, s[36:39], s92 offen  lds
    s_add_u32 m0, s91, 5280
    s_add_u32 s92, s93, 5120
    buffer_load_dwordx4 v5, s[36:39], s92 offen  lds
    s_add_u32 m0, s91, 6336
    s_add_u32 s92, s93, 6144
    buffer_load_dwordx4 v5, s[36:39], s92 offen  lds
    s_add_u32 m0, s91, 7392
    s_add_u32 s92, s93, 7168
    buffer_load_dwordx4 v5, s[36:39], s92 offen  lds
    s_xor_b32 s93, s87, 1
    s_lshl_b32 s93, s93, 3
    s_add_u32 s93, s93, s95
    s_lshl_b32 s93, s93, 3
    s_mul_i32 s91, s93, 1056
    s_lshl_b32 s93, s93, 10
    s_add_u32 s93, s93, s90
    s_add_u32 m0, s91, 0
    s_add_u32 s92, s93, 0
    buffer_load_dwordx4 v5, s[36:39], s92 offen  lds
    s_add_u32 m0, s91, 1056
    s_add_u32 s92, s93, 1024
    buffer_load_dwordx4 v5, s[36:39], s92 offen  lds
    s_add_u32 m0, s91, 2112
    s_add_u32 s92, s93, 2048
    buffer_load_dwordx4 v5, s[36:39], s92 offen  lds
    s_add_u32 m0, s91, 3168
    s_add_u32 s92, s93, 3072
    buffer_load_dwordx4 v5, s[36:39], s92 offen  lds
    s_add_u32 m0, s91, 4224
    s_add_u32 s92, s93, 4096
    buffer_load_dwordx4 v5, s[36:39], s92 offen  lds
    s_add_u32 m0, s91, 5280
    s_add_u32 s92, s93, 5120
    buffer_load_dwordx4 v5, s[36:39], s92 offen  lds
    s_add_u32 m0, s91, 6336
    s_add_u32 s92, s93, 6144
    buffer_load_dwordx4 v5, s[36:39], s92 offen  lds
    s_add_u32 m0, s91, 7392
    s_add_u32 s92, s93, 7168
    buffer_load_dwordx4 v5, s[36:39], s92 offen  lds
    s_waitcnt vmcnt(0)
    s_barrier
    s_barrier
    s_barrier
    s_barrier
    s_barrier
    s_cmp_ge_u32 s84, 9
    s_cbranch_scc1 L_Xhelp
    s_mov_b32 s90, 165888
    v_mul_u32_u24 v6, s90, v4
    v_lshl_add_u32 v6, v3, 3, v6
    s_mul_i32 s90, s95, 663552
    s_lshl_b32 s91, s83, 7
    s_add_u32 s90, s90, s91
    s_add_u32 s91, s90, 0
    buffer_load_dwordx2 v[20:21], v6, s[56:59], s91 offen
    s_add_u32 s91, s90, 9216
    buffer_load_dwordx2 v[22:23], v6, s[56:59], s91 offen
    s_add_u32 s91, s90, 0
    buffer_load_dwordx2 v[56:57], v6, s[60:63], s91 offen
    s_add_u32 s91, s90, 9216
    buffer_load_dwordx2 v[58:59], v6, s[60:63], s91 offen
    s_add_u32 s91, s90, 18432
    buffer_load_dwordx2 v[24:25], v6, s[56:59], s91 offen
    s_add_u32 s91, s90, 27648
    buffer_load_dwordx2 v[26:27], v6, s[56:59], s91 offen
    s_add_u32 s91, s90, 18432
    buffer_load_dwordx2 v[60:61], v6, s[60:63], s91 offen
    s_add_u32 s91, s90, 27648
    buffer_load_dwordx2 v[62:63], v6, s[60:63], s91 offen
    s_add_u32 s91, s90, 36864
    buffer_load_dwordx2 v[28:29], v6, s[56:59], s91 offen
    s_add_u32 s91, s90, 46080
    buffer_load_dwordx2 v[30:31], v6, s[56:59], s91 offen
    s_add_u32 s91, s90, 36864
    buffer_load_dwordx2 v[64:65], v6, s[60:63], s91 offen
    s_add_u32 s91, s90, 46080
    buffer_load_dwordx2 v[66:67], v6, s[60:63], s91 offen
    s_add_u32 s91, s90, 55296
    buffer_load_dwordx2 v[32:33], v6, s[56:59], s91 offen
    s_add_u32 s91, s90, 64512
    buffer_load_dwordx2 v[34:35], v6, s[56:59], s91 offen
    s_add_u32 s91, s90, 55296
    buffer_load_dwordx2 v[68:69], v6, s[60:63], s91 offen
    s_add_u32 s91, s90, 64512
    buffer_load_dwordx2 v[70:71], v6, s[60:63], s91 offen
    s_add_u32 s91, s90, 73728
    buffer_load_dwordx2 v[36:37], v6, s[56:59], s91 offen
    s_add_u32 s91, s90, 82944
    buffer_load_dwordx2 v[38:39], v6, s[56:59], s91 offen
    s_add_u32 s91, s90, 73728
    buffer_load_dwordx2 v[72:73], v6, s[60:63], s91 offen
    s_add_u32 s91, s90, 82944
    buffer_load_dwordx2 v[74:75], v6, s[60:63], s91 offen
    s_mov_b32 s94, s90
L_Xdown_loads:
    s_mov_b32 s90, 18432
    v_mul_u32_u24 v7, s90, v4
    v_lshl_add_u32 v7, v3, 3, v7
    s_mul_i32 s90, s83, 73728
    s_lshl_b32 s91, s95, 7
    s_add_u32 s90, s90, s91
    buffer_load_dwordx2 v[92:93], v7, s[64:67], s90 offen
    buffer_load_dwordx2 v[94:95], v7, s[64:67], s90 offen offset:1152
    s_add_u32 s90, s90, 2304
    buffer_load_dwordx2 v[96:97], v7, s[64:67], s90 offen
    buffer_load_dwordx2 v[98:99], v7, s[64:67], s90 offen offset:1152
    s_add_u32 s90, s90, 2304
    buffer_load_dwordx2 v[100:101], v7, s[64:67], s90 offen
    buffer_load_dwordx2 v[102:103], v7, s[64:67], s90 offen offset:1152
    s_add_u32 s90, s90, 2304
    buffer_load_dwordx2 v[104:105], v7, s[64:67], s90 offen
    buffer_load_dwordx2 v[106:107], v7, s[64:67], s90 offen offset:1152
    s_add_u32 s90, s90, 2304
    buffer_load_dwordx2 v[108:109], v7, s[64:67], s90 offen
    buffer_load_dwordx2 v[110:111], v7, s[64:67], s90 offen offset:1152
    s_add_u32 s90, s90, 2304
    buffer_load_dwordx2 v[112:113], v7, s[64:67], s90 offen
    buffer_load_dwordx2 v[114:115], v7, s[64:67], s90 offen offset:1152
    s_add_u32 s90, s90, 2304
    buffer_load_dwordx2 v[116:117], v7, s[64:67], s90 offen
    buffer_load_dwordx2 v[118:119], v7, s[64:67], s90 offen offset:1152
    s_add_u32 s90, s90, 2304
    buffer_load_dwordx2 v[120:121], v7, s[64:67], s90 offen
    buffer_load_dwordx2 v[122:123], v7, s[64:67], s90 offen offset:1152
    s_cmp_eq_u32 s80, 0
    s_cbranch_scc1 L_X0_skipgu
    s_mov_b32 s90, s94
    s_add_u32 s91, s90, 92160
    buffer_load_dwordx2 v[40:41], v6, s[56:59], s91 offen
    s_add_u32 s91, s90, 101376
    buffer_load_dwordx2 v[42:43], v6, s[56:59], s91 offen
    s_add_u32 s91, s90, 92160
    buffer_load_dwordx2 v[76:77], v6, s[60:63], s91 offen
    s_add_u32 s91, s90, 101376
    buffer_load_dwordx2 v[78:79], v6, s[60:63], s91 offen
    s_add_u32 s91, s90, 110592
    buffer_load_dwordx2 v[44:45], v6, s[56:59], s91 offen
    s_add_u32 s91, s90, 119808
    buffer_load_dwordx2 v[46:47], v6, s[56:59], s91 offen
    s_add_u32 s91, s90, 110592
    buffer_load_dwordx2 v[80:81], v6, s[60:63], s91 offen
    s_add_u32 s91, s90, 119808
    buffer_load_dwordx2 v[82:83], v6, s[60:63], s91 offen
    s_add_u32 s91, s90, 129024
    buffer_load_dwordx2 v[48:49], v6, s[56:59], s91 offen
    s_add_u32 s91, s90, 138240
    buffer_load_dwordx2 v[50:51], v6, s[56:59], s91 offen
    s_add_u32 s91, s90, 129024
    buffer_load_dwordx2 v[84:85], v6, s[60:63], s91 offen
    s_add_u32 s91, s90, 138240
    buffer_load_dwordx2 v[86:87], v6, s[60:63], s91 offen
    s_add_u32 s91, s90, 147456
    buffer_load_dwordx2 v[52:53], v6, s[56:59], s91 offen
    s_add_u32 s91, s90, 156672
    buffer_load_dwordx2 v[54:55], v6, s[56:59], s91 offen
    s_add_u32 s91, s90, 147456
    buffer_load_dwordx2 v[88:89], v6, s[60:63], s91 offen
    s_add_u32 s91, s90, 156672
    buffer_load_dwordx2 v[90:91], v6, s[60:63], s91 offen
L_X0_skipgu:
    v_and_b32 v10, 3, v3
    v_lshrrev_b32 v11, 1, v10
    v_and_b32 v12, 1, v10
    v_mov_b32 v15, 0x0c0c0c0c
    v_mov_b32 v13, 0x0c0c0100
    v_mov_b32 v14, 0x01000c0c
    v_cmp_eq_u32 vcc, 1, v12
    s_nop 1
    v_cndmask_b32 v13, v13, v14, vcc
    v_cmp_gt_u32 vcc, 8, v3
    s_nop 1
    v_cndmask_b32 v13, v15, v13, vcc
    v_cmp_eq_u32 vcc, 0, v11
    s_nop 1
    v_cndmask_b32 v16, v15, v13, vcc
    v_cmp_eq_u32 vcc, 1, v11
    s_nop 1
    v_cndmask_b32 v17, v15, v13, vcc
    v_mov_b32 v13, 0x0c0c0302
    v_mov_b32 v14, 0x03020c0c
    v_cmp_eq_u32 vcc, 1, v12
    s_nop 1
    v_cndmask_b32 v13, v13, v14, vcc
    v_cmp_gt_u32 vcc, 8, v3
    s_nop 1
    v_cndmask_b32 v13, v15, v13, vcc
    v_cmp_eq_u32 vcc, 0, v11
    s_nop 1
    v_cndmask_b32 v18, v15, v13, vcc
    v_cmp_eq_u32 vcc, 1, v11
    s_nop 1
    v_cndmask_b32 v19, v15, v13, vcc
    v_mul_u32_u24 v7, 144, v4
    v_add_u32 v7, v7, v3
    s_lshl_b32 s91, s95, 4
    v_add_u32 v7, s91, v7
    v_lshrrev_b32 v10, 2, v7
    v_and_b32 v11, 3, v7
    v_lshlrev_b32 v9, 13, v10
    v_lshl_add_u32 v9, v11, 4, v9
    s_cmp_eq_u32 s80, 0
    s_cbranch_scc1 L_X0_b5
    v_bfe_u32 v10, v3, 2, 1
    v_mul_u32_u24 v5, 1536, v10
    v_mul_u32_u24 v11, 48, v4
    s_mul_i32 s90, s95, 192
    s_add_u32 s90, s90, 157184
    v_add3_u32 v5, v5, v11, s90
    v_mov_b32 v144, 0
    v_mov_b32 v145, 0
    v_mov_b32 v146, 0
    v_mov_b32 v147, 0
    v_mov_b32 v148, 0
    v_mov_b32 v149, 0
    v_mov_b32 v150, 0
    v_mov_b32 v151, 0
    v_lshlrev_b32 v6, 9, v4
    v_lshl_add_u32 v6, v3, 4, v6
    s_lshl_b32 s90, s95, 10
    s_add_u32 s90, s90, 0
    v_add_u32 v6, s90, v6
    s_barrier
    ds_read_b128 v[124:127], v5
    ds_read_b128 v[128:131], v5 offset:16
    ds_read_b32 v132, v5 offset:32
    s_waitcnt vmcnt(0)
    s_waitcnt lgkmcnt(0)
    v_perm_b32 v136, v124, v124, v16
    v_perm_b32 v137, v124, v124, v17
    v_perm_b32 v138, v124, v124, v18
    v_perm_b32 v139, v124, v124, v19
    s_nop 1
    v_mfma_f32_16x16x32_bf16 v[144:147], v[136:139], v[20:23], v[144:147]
    v_mfma_f32_16x16x32_bf16 v[148:151], v[136:139], v[56:59], v[148:151]
    v_perm_b32 v140, v125, v125, v16
    v_perm_b32 v141, v125, v125, v17
    v_perm_b32 v142, v125, v125, v18
    v_perm_b32 v143, v125, v125, v19
    s_nop 1
    v_mfma_f32_16x16x32_bf16 v[144:147], v[140:143], v[24:27], v[144:147]
    v_mfma_f32_16x16x32_bf16 v[148:151], v[140:143], v[60:63], v[148:151]
    v_perm_b32 v136, v126, v126, v16
    v_perm_b32 v137, v126, v126, v17
    v_perm_b32 v138, v126, v126, v18
    v_perm_b32 v139, v126, v126, v19
    s_nop 1
    v_mfma_f32_16x16x32_bf16 v[144:147], v[136:139], v[28:31], v[144:147]
    v_mfma_f32_16x16x32_bf16 v[148:151], v[136:139], v[64:67], v[148:151]
    v_perm_b32 v140, v127, v127, v16
    v_perm_b32 v141, v127, v127, v17
    v_perm_b32 v142, v127, v127, v18
    v_perm_b32 v143, v127, v127, v19
    s_nop 1
    v_mfma_f32_16x16x32_bf16 v[144:147], v[140:143], v[32:35], v[144:147]
    v_mfma_f32_16x16x32_bf16 v[148:151], v[140:143], v[68:71], v[148:151]
    v_perm_b32 v136, v128, v128, v16
    v_perm_b32 v137, v128, v128, v17
    v_perm_b32 v138, v128, v128, v18
    v_perm_b32 v139, v128, v128, v19
    s_nop 1
    v_mfma_f32_16x16x32_bf16 v[144:147], v[136:139], v[36:39], v[144:147]
    v_mfma_f32_16x16x32_bf16 v[148:151], v[136:139], v[72:75], v[148:151]
    v_perm_b32 v140, v129, v129, v16
    v_perm_b32 v141, v129, v129, v17
    v_perm_b32 v142, v129, v129, v18
    v_perm_b32 v143, v129, v129, v19
    s_nop 1
    v_mfma_f32_16x16x32_bf16 v[144:147], v[140:143], v[40:43], v[144:147]
    v_mfma_f32_16x16x32_bf16 v[148:151], v[140:143], v[76:79], v[148:151]
    v_perm_b32 v136, v130, v130, v16
    v_perm_b32 v137, v130, v130, v17
    v_perm_b32 v138, v130, v130, v18
    v_perm_b32 v139, v130, v130, v19
    s_nop 1
    v_mfma_f32_16x16x32_bf16 v[144:147], v[136:139], v[44:47], v[144:147]
    v_mfma_f32_16x16x32_bf16 v[148:151], v[136:139], v[80:83], v[148:151]
    v_perm_b32 v140, v131, v131, v16
    v_perm_b32 v141, v131, v131, v17
    v_perm_b32 v142, v131, v131, v18
    v_perm_b32 v143, v131, v131, v19
    s_nop 1
    v_mfma_f32_16x16x32_bf16 v[144:147], v[140:143], v[48:51], v[144:147]
    v_mfma_f32_16x16x32_bf16 v[148:151], v[140:143], v[84:87], v[148:151]
    v_perm_b32 v136, v132, v132, v16
    v_perm_b32 v137, v132, v132, v17
    v_perm_b32 v138, v132, v132, v18
    v_perm_b32 v139, v132, v132, v19
    s_nop 1
    v_mfma_f32_16x16x32_bf16 v[144:147], v[136:139], v[52:55], v[144:147]
    v_mfma_f32_16x16x32_bf16 v[148:151], v[136:139], v[88:91], v[148:151]
    v_cmp_gt_u32 vcc, 2, v4
    s_and_saveexec_b64 s[96:97], vcc
    s_nop 4
    ds_write_b128 v6, v[144:147]
    ds_write_b128 v6, v[148:151] offset:256
    s_mov_b64 exec, s[96:97]
    s_waitcnt lgkmcnt(0)
    s_barrier
    s_branch L_Xdown
L_X0_tile8:
    s_movk_i32 s95, 8
    s_branch L_Xdown_loads
L_X0_b5:
    s_barrier
    s_barrier
L_Xdown:
    v_bfe_u32 v10, v3, 2, 1
    v_lshlrev_b32 v5, 7, v10
    v_lshl_add_u32 v5, v4, 5, v5
    v_add_u32 v5, 160256, v5
    s_lshl_b32 s90, s83, 6
    s_add_u32 s90, s90, 7340032
    s_mov_b32 s28, 0x05040100
    s_mov_b32 s29, 0x07060302
    s_waitcnt vmcnt(0)
    v_perm_b32 v20, v94, v92, s28
    v_perm_b32 v21, v98, v96, s28
    v_perm_b32 v22, v102, v100, s28
    v_perm_b32 v23, v106, v104, s28
    v_perm_b32 v24, v94, v92, s29
    v_perm_b32 v25, v98, v96, s29
    v_perm_b32 v26, v102, v100, s29
    v_perm_b32 v27, v106, v104, s29
    v_perm_b32 v28, v95, v93, s28
    v_perm_b32 v29, v99, v97, s28
    v_perm_b32 v30, v103, v101, s28
    v_perm_b32 v31, v107, v105, s28
    v_perm_b32 v32, v95, v93, s29
    v_perm_b32 v33, v99, v97, s29
    v_perm_b32 v34, v103, v101, s29
    v_perm_b32 v35, v107, v105, s29
    v_perm_b32 v36, v110, v108, s28
    v_perm_b32 v37, v114, v112, s28
    v_perm_b32 v38, v118, v116, s28
    v_perm_b32 v39, v122, v120, s28
    v_perm_b32 v40, v110, v108, s29
    v_perm_b32 v41, v114, v112, s29
    v_perm_b32 v42, v118, v116, s29
    v_perm_b32 v43, v122, v120, s29
    v_perm_b32 v44, v111, v109, s28
    v_perm_b32 v45, v115, v113, s28
    v_perm_b32 v46, v119, v117, s28
    v_perm_b32 v47, v123, v121, s28
    v_perm_b32 v48, v111, v109, s29
    v_perm_b32 v49, v115, v113, s29
    v_perm_b32 v50, v119, v117, s29
    v_perm_b32 v51, v123, v121, s29
    v_mov_b32 v52, 0
    v_mov_b32 v53, 0
    v_mov_b32 v54, 0
    v_mov_b32 v55, 0
    v_mov_b32 v56, 0
    v_mov_b32 v57, 0
    v_mov_b32 v58, 0
    v_mov_b32 v59, 0
    v_mov_b32 v60, 0
    v_mov_b32 v61, 0
    v_mov_b32 v62, 0
    v_mov_b32 v63, 0
    v_mov_b32 v64, 0
    v_mov_b32 v65, 0
    v_mov_b32 v66, 0
    v_mov_b32 v67, 0
    s_barrier
    ds_read_b128 v[124:127], v5
    ds_read_b128 v[128:131], v5 offset:16
    s_waitcnt lgkmcnt(0)
    v_mfma_f32_16x16x32_bf16 v[52:55], v[124:127], v[20:23], v[52:55]
    v_mfma_f32_16x16x32_bf16 v[56:59], v[124:127], v[24:27], v[56:59]
    v_mfma_f32_16x16x32_bf16 v[60:63], v[124:127], v[28:31], v[60:63]
    v_mfma_f32_16x16x32_bf16 v[64:67], v[124:127], v[32:35], v[64:67]
    v_mfma_f32_16x16x32_bf16 v[52:55], v[128:131], v[36:39], v[52:55]
    v_mfma_f32_16x16x32_bf16 v[56:59], v[128:131], v[40:43], v[56:59]
    v_mfma_f32_16x16x32_bf16 v[60:63], v[128:131], v[44:47], v[60:63]
    v_mfma_f32_16x16x32_bf16 v[64:67], v[128:131], v[48:51], v[64:67]
    s_nop 5
    v_cvt_pk_bf16_f32 v152, v52, v56
    s_nop 0
    v_cvt_pk_bf16_f32 v153, v60, v64
    v_mov_b32 v154, s88
    v_mov_b32 v155, s89
    v_cmp_gt_u32 vcc, 2, v4
    s_and_saveexec_b64 s[96:97], vcc
    buffer_store_dwordx4 v[152:155], v9, s[76:79], s90 offen sc1
    s_mov_b64 exec, s[96:97]
    s_branch L_fin
L_Xhelp:
    s_sub_u32 s90, s84, 9
    s_lshl_b32 s90, s90, 3
    s_add_u32 s90, s90, s95
    v_add_u32 v6, 0, v2
    v_mul_u32_u24 v6, 56, v6
    v_add_u32 v6, s90, v6
    s_movk_i32 s91, 7282
    v_mul_u32_u24 v7, s91, v6
    v_lshrrev_b32 v7, 16, v7
    v_mul_u32_u24 v8, 9, v7
    v_sub_u32 v8, v6, v8
    v_and_b32 v9, 255, v7
    v_lshrrev_b32 v10, 3, v9
    v_mul_u32_u24 v10, 18, v10
    v_and_b32 v11, 7, v9
    v_add3_u32 v10, v10, v11, 10
    s_movk_i32 s91, 9216
    v_mul_lo_u32 v10, v10, s91
    v_lshl_add_u32 v10, v8, 7, v10
    s_mul_i32 s91, s81, 1152
    v_add_u32 v10, s91, v10
    s_movk_i32 s91, 4608
    v_cmp_gt_u32 vcc, s91, v6
    s_and_saveexec_b64 s[96:97], vcc
    s_movk_i32 s91, 256
    v_cmp_gt_u32 vcc, s91, v7
    s_and_saveexec_b64 s[92:93], vcc
    buffer_load_dword v16, v10, s[56:59], 0 offen
    s_andn2_b64 exec, s[92:93], exec
    buffer_load_dword v17, v10, s[60:63], 0 offen
    s_mov_b64 exec, s[96:97]
    v_add_u32 v6, 64, v2
    v_mul_u32_u24 v6, 56, v6
    v_add_u32 v6, s90, v6
    s_movk_i32 s91, 7282
    v_mul_u32_u24 v7, s91, v6
    v_lshrrev_b32 v7, 16, v7
    v_mul_u32_u24 v8, 9, v7
    v_sub_u32 v8, v6, v8
    v_and_b32 v9, 255, v7
    v_lshrrev_b32 v10, 3, v9
    v_mul_u32_u24 v10, 18, v10
    v_and_b32 v11, 7, v9
    v_add3_u32 v10, v10, v11, 10
    s_movk_i32 s91, 9216
    v_mul_lo_u32 v10, v10, s91
    v_lshl_add_u32 v10, v8, 7, v10
    s_mul_i32 s91, s81, 1152
    v_add_u32 v10, s91, v10
    s_movk_i32 s91, 4608
    v_cmp_gt_u32 vcc, s91, v6
    s_and_saveexec_b64 s[96:97], vcc
    s_movk_i32 s91, 256
    v_cmp_gt_u32 vcc, s91, v7
    s_and_saveexec_b64 s[92:93], vcc
    buffer_load_dword v18, v10, s[56:59], 0 offen
    s_andn2_b64 exec, s[92:93], exec
    buffer_load_dword v19, v10, s[60:63], 0 offen
    s_mov_b64 exec, s[96:97]
    s_waitcnt vmcnt(0)
    s_branch L_fin
L_fin:
L_end:
    s_endpgm

.section .rodata,"a"
.p2align 6
.amdhsa_kernel sequential_preLN__compressed_kv_cla__swiglu_ffn__decode_kernel
  .amdhsa_next_free_vgpr 168
  .amdhsa_next_free_sgpr 102
  .amdhsa_accum_offset 168
  .amdhsa_group_segment_fixed_size 0
  .amdhsa_kernarg_size 104
  .amdhsa_user_sgpr_count 2
  .amdhsa_user_sgpr_kernarg_segment_ptr 1
  .amdhsa_system_sgpr_workgroup_id_x 1
.end_amdhsa_kernel
```
